```python
import torch

def _softmax(x, axis=-1):
    return torch.softmax(x, dim=axis)
def _gelu(x):
    return torch.nn.functional.gelu(x, approximate="tanh")
def _silu(x):
    return torch.nn.functional.silu(x)
def _sigmoid(x):
    return torch.sigmoid(x)
def _layernorm(x, axis=-1, eps=1e-5):
    m = x.mean(dim=axis, keepdim=True)
    v = x.var(dim=axis, keepdim=True, unbiased=False)
    return (x - m) / torch.sqrt(v + eps)
def _scatter_add(tgt, idx, src, axis=0):
    return tgt.clone().index_add_(axis, idx, src)
def _segment_sum(src, seg, n):
    out = torch.zeros((n,) + src.shape[1:], dtype=src.dtype)
    return out.index_add_(0, seg, src)
def _pad(x, pw):
    flat = tuple(v for pair in reversed(pw) for v in pair)
    return torch.nn.functional.pad(x, flat)

kernel_name = 'gated_mix__ssm_conv_s5__glu_gated_swiglu__prompt'

def setup_inputs():

    _w = (lambda a: (lambda t: t.to(torch.bfloat16) if t.is_floating_point() else t)(torch.as_tensor(a)))
    def _A_setup():
        B, S, D = 1, 2048, 512
        P = D
        Lambda_re = -0.5 * (lambda _x: torch.exp(torch.as_tensor(_x)))((lambda *s: torch.randn(*s, dtype=torch.bfloat16) * 0.2)(P))
        Lambda_im = (lambda *s: torch.randn(*s, dtype=torch.bfloat16) * 0.4)(P) * 1.0
        B_re = (lambda *s: torch.randn(*s, dtype=torch.bfloat16) * 0.2)(P, D) * (D ** -0.5)
        B_im = (lambda *s: torch.randn(*s, dtype=torch.bfloat16) * 0.2)(P, D) * (D ** -0.5)
        C_re = (lambda *s: torch.randn(*s, dtype=torch.bfloat16) * 0.2)(D, P) * (P ** -0.5)
        C_im = (lambda *s: torch.randn(*s, dtype=torch.bfloat16) * 0.2)(D, P) * (P ** -0.5)
        log_dt = (lambda *s: torch.randn(*s, dtype=torch.bfloat16) * 0.2)(P) * 0.3 - 2.0
        Dskip = (lambda *s: torch.randn(*s, dtype=torch.bfloat16) * 0.05)(D)
        return {
            "x": _w((lambda *s: torch.randn(*s, dtype=torch.bfloat16) * 0.05)(B, S, D)),
            "Lambda_re": _w(Lambda_re),
            "Lambda_im": _w(Lambda_im),
            "B_re": _w(B_re),
            "B_im": _w(B_im),
            "C_re": _w(C_re),
            "C_im": _w(C_im),
            "log_dt": _w(log_dt),
            "Dskip": _w(Dskip),
        }
    _A_in = _A_setup()

    def _B_setup():
        B, S, D, F = 1, 2048, 512, 1792
        return {
            "x": _w((lambda *s: torch.randn(*s, dtype=torch.bfloat16) * 0.05)(B, S, D)),
            "w1": _w((lambda *s: torch.randn(*s, dtype=torch.bfloat16) * 0.8)(D, F) * (2.0 / D) ** 0.5),
            "w3": _w((lambda *s: torch.randn(*s, dtype=torch.bfloat16) * 0.8)(D, F) * (2.0 / D) ** 0.5),
            "w2": _w((lambda *s: torch.randn(*s, dtype=torch.bfloat16) * 0.8)(F, D) * (2.0 / F) ** 0.5),
        }
    _B_in = _B_setup()

    return {
        "A_x": _A_in["x"],
        "A_Lambda_re": _A_in["Lambda_re"],
        "A_Lambda_im": _A_in["Lambda_im"],
        "A_B_re": _A_in["B_re"],
        "A_B_im": _A_in["B_im"],
        "A_C_re": _A_in["C_re"],
        "A_C_im": _A_in["C_im"],
        "A_log_dt": _A_in["log_dt"],
        "A_Dskip": _A_in["Dskip"],
        "B_x": _B_in["x"],
        "B_w1": _B_in["w1"],
        "B_w3": _B_in["w3"],
        "B_w2": _B_in["w2"],
        "gate_w": _w((lambda *s: torch.randn(*s, dtype=torch.bfloat16) * 0.05)(512) * 16.0),
    }

def reference(A_x, A_Lambda_re, A_Lambda_im, A_B_re, A_B_im, A_C_re, A_C_im, A_log_dt, A_Dskip, B_x, B_w1, B_w3, B_w2, gate_w):
    def _A_ref(x, Lambda_re, Lambda_im, B_re, B_im, C_re, C_im, log_dt, Dskip):
        Bsz, L, H = x.shape
        Lam = Lambda_re + 1j * Lambda_im
        Bmat = B_re + 1j * B_im
        Cmat = C_re + 1j * C_im
        dt = torch.exp(log_dt)
        Lam_bar = torch.exp(dt * Lam)
        B_bar = ((Lam_bar - 1.0) / Lam)[:, None] * Bmat
        Bu = torch.einsum("bld,pd->blp", x + 0j, B_bar)
        h = torch.zeros_like(Bu[:, 0, :])
        hs = []
        for t in range(L):
            h = Lam_bar[None, :] * h + Bu[:, t, :]
            hs.append(h)
        hseq = torch.stack(hs, 1)
        y = 2.0 * torch.einsum("blp,dp->bld", hseq, Cmat).real + x * Dskip[None, None, :]
        return y

    def _B_ref(x, w1, w3, w2):
        gate = torch.einsum("bsd,df->bsf", x, w1)
        up = torch.einsum("bsd,df->bsf", x, w3)
        h = _silu(gate) * up
        out = torch.einsum("bsf,fd->bsd", h, w2)
        return out

    x = A_x
    g = _sigmoid((x * gate_w).sum(-1, keepdims=True))
    a = _A_ref(x, A_Lambda_re, A_Lambda_im, A_B_re, A_B_im, A_C_re, A_C_im, A_log_dt, A_Dskip)
    b = _B_ref(x, B_w1, B_w3, B_w2)
    return g * a + (1 - g) * b
```

```asm
; @launch grid=(256,1,1) block=(512,1,1) lds=163840
.amdgcn_target "amdgcn-amd-amdhsa--gfx950"
.text
.globl gated_mix__ssm_conv_s5__glu_gated_swiglu__prompt_kernel
.p2align 8
.type gated_mix__ssm_conv_s5__glu_gated_swiglu__prompt_kernel,@function
gated_mix__ssm_conv_s5__glu_gated_swiglu__prompt_kernel:
  s_cmp_ge_u32 s2, 256
  s_cbranch_scc1 Lexit
  s_load_dwordx16 s[36:51], s[0:1], 0
  s_load_dwordx16 s[52:67], s[0:1], 64
  s_load_dwordx2 s[68:69], s[0:1], 128
  v_lshrrev_b32 v1, 6, v0
  v_and_b32 v220, 63, v0
  v_readfirstlane_b32 s4, v1
  v_lshlrev_b32 v219, 4, v220
  s_and_b32 s3, s2, 1
  s_lshl_b32 s3, s3, 3
  s_bfe_u32 s5, s2, 0x30003
  s_add_u32 s5, s5, s3
  s_bfe_u32 s3, s2, 0x20001
  s_lshr_b32 s6, s2, 6
  s_lshl_b32 s6, s6, 2
  s_add_u32 s6, s6, s3
  s_and_b32 s7, s4, 3
  s_lshr_b32 s70, s4, 2
  s_lshl_b32 s71, s4, 11
  s_lshl_b32 s72, s4, 10
  s_lshl_b32 s73, s70, 13
  s_lshl_b32 s3, s7, 10
  s_add_u32 s73, s73, s3
  v_lshrrev_b32 v1, 3, v220
  v_and_b32 v2, 7, v220
  s_lshl_b32 s3, s4, 4
  s_add_u32 s3, s3, 0
  v_add_u32 v3, s3, v1
  v_and_b32 v4, 31, v3
  v_and_b32 v214, 4, v4
  v_lshlrev_b32 v214, 2, v214
  v_and_or_b32 v214, v4, 3, v214
  v_lshrrev_b32 v5, 3, v4
  v_lshl_or_b32 v214, v5, 2, v214
  v_and_b32 v4, 0x60, v3
  v_add_u32 v214, v214, v4
  s_lshl_b32 s3, s5, 7
  v_add_u32 v214, s3, v214
  v_bfe_u32 v3, v3, 1, 3
  v_xor_b32 v3, v3, v2
  v_lshlrev_b32 v3, 4, v3
  v_lshl_add_u32 v214, v214, 10, v3
  s_lshl_b32 s3, s4, 4
  s_add_u32 s3, s3, 8
  v_add_u32 v3, s3, v1
  v_and_b32 v4, 31, v3
  v_and_b32 v215, 4, v4
  v_lshlrev_b32 v215, 2, v215
  v_and_or_b32 v215, v4, 3, v215
  v_lshrrev_b32 v5, 3, v4
  v_lshl_or_b32 v215, v5, 2, v215
  v_and_b32 v4, 0x60, v3
  v_add_u32 v215, v215, v4
  s_lshl_b32 s3, s5, 7
  v_add_u32 v215, s3, v215
  v_bfe_u32 v3, v3, 1, 3
  v_xor_b32 v3, v3, v2
  v_lshlrev_b32 v3, 4, v3
  v_lshl_add_u32 v215, v215, 10, v3
  v_subrev_u32 v215, 1024, v215
  s_lshl_b32 s3, s4, 3
  v_add_u32 v3, s3, v1
  v_mul_u32_u24 v3, 3584, v3
  s_lshl_b32 s3, s6, 8
  v_add_u32 v3, s3, v3
  v_and_b32 v4, 2, v1
  v_xor_b32 v4, v4, v2
  v_lshl_add_u32 v216, v4, 4, v3
  v_xor_b32 v4, 4, v4
  v_lshl_add_u32 v217, v4, 4, v3
  s_lshr_b32 s97, s6, 2
  s_add_u32 s97, s97, s5
  s_lshl_b32 s97, s97, 2
  s_and_b32 s3, s97, 7
  s_lshl_b32 s96, s3, 7
  s_mul_i32 s94, s3, 229376
  s_cmp_lt_u32 s6, 14
  s_cselect_b32 s14, 1835008, 0
  s_cselect_b32 s18, 1836032, 0
  s_cselect_b32 s34, 14680064, 0
  s_mov_b32 s10, 2097152
  s_mov_b32 s11, 0x20000
  s_mov_b32 s15, 0x20000
  s_mov_b32 s19, 0x20000
  s_mov_b32 s35, 0x20000
  s_lshl_b32 s3, s6, 1
  s_add_u32 s3, s3, s70
  s_lshl_b32 s3, s3, 5
  v_and_b32 v6, 15, v220
  v_lshl_add_u32 v6, v6, 1, s3
  s_waitcnt lgkmcnt(0)
  global_load_ushort v242, v6, s[38:39]
  global_load_ushort v243, v6, s[40:41]
  global_load_ushort v244, v6, s[50:51]
  s_mov_b32 s8, s36
  s_mov_b32 s9, s37
  s_add_u32 m0, s71, 0
  s_nop 0
  buffer_load_dwordx4 v214, s[8:11], s96 offen lds
  buffer_load_dwordx4 v215, s[8:11], s96 offen offset:1024 lds
  s_mov_b32 s12, s56
  s_mov_b32 s13, s57
  s_sub_u32 s16, s58, 1024
  s_subb_u32 s17, s59, 0
  s_add_u32 m0, s71, 65536
  s_nop 0
  buffer_load_dwordx4 v216, s[12:15], s94 offen lds
  buffer_load_dwordx4 v217, s[16:19], s94 offen offset:1024 lds
  s_mov_b32 s32, s68
  s_mov_b32 s33, s69
  s_mov_b32 s28, s68
  s_mov_b32 s29, s69
  s_mov_b32 s30, 14680064
  s_mov_b32 s31, 0x20000
  s_mov_b32 s88, s68
  s_mov_b32 s89, s69
  s_mov_b32 s90, 4096
  s_mov_b32 s91, 0x20000
  s_lshl_b32 s3, s6, 13
  s_add_u32 s3, s3, 12713984
  s_add_u32 s88, s88, s3
  s_addc_u32 s89, s89, 0
  s_mov_b32 s20, s42
  s_mov_b32 s21, s43
  s_mov_b32 s22, 524288
  s_mov_b32 s23, 0x20000
  s_mov_b32 s24, s44
  s_mov_b32 s25, s45
  s_mov_b32 s26, 524288
  s_mov_b32 s27, 0x20000
  s_add_u32 s3, s97, 0
  s_and_b32 s3, s3, 7
  s_lshl_b32 s38, s3, 7
  s_mul_i32 s50, s3, 229376
  s_add_u32 s3, s97, 1
  s_and_b32 s3, s3, 7
  s_lshl_b32 s39, s3, 7
  s_mul_i32 s51, s3, 229376
  s_add_u32 s3, s97, 2
  s_and_b32 s3, s3, 7
  s_lshl_b32 s40, s3, 7
  s_mul_i32 s54, s3, 229376
  s_add_u32 s3, s97, 3
  s_and_b32 s3, s3, 7
  s_lshl_b32 s41, s3, 7
  s_mul_i32 s55, s3, 229376
  s_add_u32 s3, s97, 4
  s_and_b32 s3, s3, 7
  s_lshl_b32 s42, s3, 7
  s_mul_i32 s56, s3, 229376
  s_add_u32 s3, s97, 5
  s_and_b32 s3, s3, 7
  s_lshl_b32 s43, s3, 7
  s_mul_i32 s57, s3, 229376
  s_add_u32 s3, s97, 6
  s_and_b32 s3, s3, 7
  s_lshl_b32 s44, s3, 7
  s_mul_i32 s58, s3, 229376
  s_add_u32 s3, s97, 7
  s_and_b32 s3, s3, 7
  s_lshl_b32 s45, s3, 7
  s_mul_i32 s59, s3, 229376
  s_cmp_eq_u32 s70, 0
  s_cselect_b32 s98, s38, s40
  s_cmp_eq_u32 s70, 0
  s_cselect_b32 s99, s39, s41
  s_cmp_eq_u32 s70, 0
  s_cselect_b32 s100, s42, s44
  s_cmp_eq_u32 s70, 0
  s_cselect_b32 s101, s43, s45
  s_cmp_lg_u32 s6, 15
  s_cbranch_scc1 L1
  s_cmp_ge_u32 s4, 5
  s_cbranch_scc1 L1
  s_lshl_b32 s3, s5, 13
  s_add_u32 s3, s3, s72
  s_add_u32 s3, s3, 12713984
  v_mov_b32 v8, -1
  v_mov_b32 v9, -1
  v_mov_b32 v10, -1
  v_mov_b32 v11, -1
  buffer_store_dwordx4 v[8:11], v219, s[28:31], s3 offen sc1
  s_waitcnt vmcnt(0)
L1:
  s_cmp_lg_u32 s6, 14
  s_cbranch_scc1 L2
  s_cmp_lg_u32 s4, 0
  s_cbranch_scc1 L2
  s_mov_b32 m0, 148480
  s_nop 0
  global_load_lds_dwordx4 v219, s[62:63]
L2:
  s_barrier
  s_add_u32 m0, s71, 16384
  s_nop 0
  buffer_load_dwordx4 v214, s[8:11], s39 offen lds
  buffer_load_dwordx4 v215, s[8:11], s39 offen offset:1024 lds
  s_add_u32 m0, s71, 81920
  s_nop 0
  buffer_load_dwordx4 v216, s[12:15], s51 offen lds
  buffer_load_dwordx4 v217, s[16:19], s51 offen offset:1024 lds
  s_lshl_b32 s3, s7, 3
  v_add_u32 v3, s3, v1
  v_bfe_u32 v4, v3, 1, 3
  v_xor_b32 v4, v4, v2
  s_lshl_b32 s3, s6, 5
  v_add_u32 v3, s3, v3
  v_lshlrev_b32 v3, 10, v3
  v_lshl_add_u32 v218, v4, 4, v3
  v_and_b32 v3, 31, v220
  v_lshrrev_b32 v4, 5, v220
  v_bfe_u32 v5, v3, 1, 3
  v_xor_b32 v4, v4, v5
  s_lshl_b32 s3, s7, 12
  v_lshl_add_u32 v3, v3, 7, s3
  v_lshl_add_u32 v208, v4, 4, v3
  v_xor_b32 v209, 32, v208
  v_xor_b32 v210, 64, v208
  v_xor_b32 v211, 96, v208
  v_lshrrev_b32 v3, 5, v220
  v_bfe_u32 v4, v220, 2, 2
  v_lshl_add_u32 v3, v3, 4, v4
  v_lshlrev_b32 v3, 7, v3
  v_and_b32 v4, 3, v220
  v_lshl_add_u32 v3, v4, 3, v3
  v_bfe_u32 v4, v220, 4, 1
  v_lshl_add_u32 v3, v4, 10, v3
  v_bfe_u32 v4, v220, 3, 2
  s_lshl_b32 s3, s70, 1
  v_xor_b32 v4, s3, v4
  v_lshl_add_u32 v3, v4, 5, v3
  v_add_u32 v212, 0x10000, v3
  v_xor_b32 v213, 32, v212
  s_lshl_b32 s3, s5, 2
  s_add_u32 s3, s3, s7
  s_mul_i32 s95, s3, 180224
  s_lshl_b32 s3, s6, 13
  s_add_u32 s75, s95, s3
  s_lshl_b32 s3, s70, 11
  s_add_u32 s75, s75, s3
  s_lshl_b32 s3, s6, 1
  s_add_u32 s3, s3, s70
  s_add_u32 s3, s3, 112
  s_lshl_b32 s3, s3, 10
  s_add_u32 s95, s95, s3
  s_mov_b32 s76, 0xffff0000
  s_mov_b32 s77, 0xffff0000
  s_mov_b32 s78, 0
  s_mov_b32 s79, 0xffff
  s_mov_b32 s80, 0
  s_mov_b32 s81, 0xffff0000
  s_cmp_eq_u32 s7, 1
  s_cselect_b64 s[82:83], -1, 0
  s_cmp_eq_u32 s7, 2
  s_cselect_b64 s[84:85], -1, 0
  s_cmp_eq_u32 s7, 3
  s_cselect_b64 s[86:87], -1, 0
  v_and_b32 v221, 15, v220
  s_lshl_b32 s3, s4, 7
  s_add_u32 s3, s3, 147456
  v_lshl_add_u32 v221, v221, 3, s3
  s_waitcnt vmcnt(8)
  v_lshlrev_b32 v242, 16, v242
  v_lshlrev_b32 v243, 16, v243
  v_lshlrev_b32 v244, 16, v244
  v_mul_f32 v244, 0x3fb8aa3b, v244
  v_exp_f32 v244, v244
  s_nop 0
  v_cvt_pk_bf16_f32 v244, v244, v244
  v_lshlrev_b32 v244, 16, v244
  v_mul_f32 v248, v244, v242
  v_mul_f32 v249, v244, v243
  v_mul_f32 v248, 0x3fb8aa3b, v248
  v_mul_f32 v249, 0.15915494, v249
  v_rndne_f32 v246, v249
  v_exp_f32 v247, v248
  v_sub_f32 v246, v249, v246
  v_cos_f32 v222, v246
  v_sin_f32 v223, v246
  s_nop 0
  v_mul_f32 v222, v222, v247
  v_mul_f32 v223, v223, v247
  v_mul_f32 v246, v242, v242
  v_fmac_f32 v246, v243, v243
  v_rcp_f32 v246, v246
  v_add_f32 v247, -1.0, v222
  v_add_f32 v246, v246, v246
  v_mul_f32 v240, v247, v242
  v_mul_f32 v241, v223, v242
  v_fmac_f32 v240, v223, v243
  v_fma_f32 v241, -v247, v243, v241
  v_mul_f32 v240, v240, v246
  v_mul_f32 v241, v241, v246
  v_lshrrev_b32 v245, 4, v220
  v_lshlrev_b32 v245, 3, v245
  v_cvt_f32_u32 v245, v245
  v_mul_f32 v242, v248, v245
  v_mul_f32 v243, v249, v245
  v_rndne_f32 v246, v243
  v_exp_f32 v247, v242
  v_sub_f32 v246, v243, v246
  v_cos_f32 v236, v246
  v_sin_f32 v237, v246
  s_nop 0
  v_mul_f32 v236, v236, v247
  v_mul_f32 v237, v237, v247
  s_lshl_b32 s3, s7, 5
  v_cvt_f32_u32 v244, s3
  v_add_f32 v245, v245, v244
  v_mul_f32 v242, v248, v245
  v_mul_f32 v243, v249, v245
  v_rndne_f32 v246, v243
  v_exp_f32 v247, v242
  v_sub_f32 v246, v243, v246
  v_cos_f32 v238, v246
  v_sin_f32 v239, v246
  s_nop 0
  v_mul_f32 v238, v238, v247
  v_mul_f32 v239, v239, v247
  v_mul_f32 v246, v223, v223
  v_mul_f32 v247, v222, v223
  v_fma_f32 v224, v222, v222, -v246
  v_add_f32 v225, v247, v247
  v_mul_f32 v246, v225, v225
  v_mul_f32 v247, v224, v225
  v_fma_f32 v224, v224, v224, -v246
  v_add_f32 v225, v247, v247
  v_mul_f32 v246, v225, v225
  v_mul_f32 v247, v224, v225
  v_fma_f32 v224, v224, v224, -v246
  v_add_f32 v225, v247, v247
  v_mul_f32 v246, v225, v225
  v_mul_f32 v247, v224, v225
  v_fma_f32 v226, v224, v224, -v246
  v_add_f32 v227, v247, v247
  v_mul_f32 v246, v227, v227
  v_mul_f32 v247, v226, v227
  v_fma_f32 v228, v226, v226, -v246
  v_add_f32 v229, v247, v247
  v_mul_f32 v246, v229, v229
  v_mul_f32 v247, v228, v229
  v_fma_f32 v230, v228, v228, -v246
  v_add_f32 v231, v247, v247
  v_mul_f32 v246, v231, v231
  v_mul_f32 v247, v230, v231
  v_fma_f32 v230, v230, v230, -v246
  v_add_f32 v231, v247, v247
  v_mul_f32 v246, v231, v231
  v_mul_f32 v247, v230, v231
  v_fma_f32 v232, v230, v230, -v246
  v_add_f32 v233, v247, v247
  v_mul_f32 v246, v233, v233
  v_mul_f32 v247, v232, v233
  v_fma_f32 v232, v232, v232, -v246
  v_add_f32 v233, v247, v247
  v_mul_f32 v246, v233, v233
  v_mul_f32 v247, v232, v233
  v_fma_f32 v234, v232, v232, -v246
  v_add_f32 v235, v247, v247
  s_cmp_ge_u32 s6, 14
  s_cbranch_scc1 Lzpath
  s_waitcnt vmcnt(4) lgkmcnt(0)
  s_barrier
  s_cmp_lg_u32 s6, 15
  s_cbranch_scc1 L3
  s_cmp_lg_u32 s4, 0
  s_cbranch_scc1 L3
  s_lshl_b32 s3, s5, 2
  v_mov_b32 v1, s3
  v_mov_b32 v2, 1
  s_mov_b64 exec, 1
  global_store_dword v1, v2, s[66:67] sc1
  s_mov_b64 exec, -1
L3:
  ds_read_b128 v[0:3], v208 offset:0
  ds_read_b64_tr_b16 v[176:177], v212 offset:0
  ds_read_b64_tr_b16 v[178:179], v212 offset:512
  ds_read_b64_tr_b16 v[180:181], v213 offset:0
  ds_read_b64_tr_b16 v[182:183], v213 offset:512
  ds_read_b128 v[4:7], v209 offset:0
  ds_read_b64_tr_b16 v[184:185], v212 offset:4096
  ds_read_b64_tr_b16 v[186:187], v212 offset:4608
  ds_read_b64_tr_b16 v[188:189], v213 offset:4096
  ds_read_b64_tr_b16 v[190:191], v213 offset:4608
  s_waitcnt lgkmcnt(0)
  s_add_u32 m0, s71, 32768
  v_mfma_f32_32x32x16_bf16 v[128:143], v[176:179], v[0:3], 0
  ds_read_b128 v[8:11], v210 offset:0
  ds_read_b64_tr_b16 v[192:193], v212 offset:8192
  ds_read_b64_tr_b16 v[194:195], v212 offset:8704
  ds_read_b64_tr_b16 v[196:197], v213 offset:8192
  buffer_load_dwordx4 v214, s[8:11], s40 offen lds
  v_mfma_f32_32x32x16_bf16 v[144:159], v[180:183], v[0:3], 0
  ds_read_b64_tr_b16 v[198:199], v213 offset:8704
  ds_read_b128 v[12:15], v211 offset:0
  ds_read_b64_tr_b16 v[200:201], v212 offset:12288
  ds_read_b64_tr_b16 v[202:203], v212 offset:12800
  buffer_load_dwordx4 v215, s[8:11], s40 offen offset:1024 lds
  s_add_u32 m0, s71, 98304
  v_mfma_f32_32x32x16_bf16 v[128:143], v[184:187], v[4:7], v[128:143]
  ds_read_b64_tr_b16 v[204:205], v213 offset:12288
  ds_read_b64_tr_b16 v[206:207], v213 offset:12800
  buffer_load_dwordx4 v216, s[12:15], s54 offen lds
  v_mfma_f32_32x32x16_bf16 v[144:159], v[188:191], v[4:7], v[144:159]
  buffer_load_dwordx4 v217, s[16:19], s54 offen offset:1024 lds
  s_waitcnt lgkmcnt(0)
  v_mfma_f32_32x32x16_bf16 v[128:143], v[192:195], v[8:11], v[128:143]
  s_waitcnt vmcnt(4) lgkmcnt(0)
  s_barrier
  s_add_u32 m0, s71, 49152
  v_mfma_f32_32x32x16_bf16 v[144:159], v[196:199], v[8:11], v[144:159]
  ds_read_b128 v[16:19], v208 offset:16384
  ds_read_b64_tr_b16 v[176:177], v212 offset:16384
  ds_read_b64_tr_b16 v[178:179], v212 offset:16896
  ds_read_b64_tr_b16 v[180:181], v213 offset:16384
  buffer_load_dwordx4 v214, s[8:11], s41 offen lds
  v_mfma_f32_32x32x16_bf16 v[128:143], v[200:203], v[12:15], v[128:143]
  ds_read_b64_tr_b16 v[182:183], v213 offset:16896
  ds_read_b128 v[20:23], v209 offset:16384
  ds_read_b64_tr_b16 v[184:185], v212 offset:20480
  ds_read_b64_tr_b16 v[186:187], v212 offset:20992
  buffer_load_dwordx4 v215, s[8:11], s41 offen offset:1024 lds
  s_add_u32 m0, s71, 114688
  v_mfma_f32_32x32x16_bf16 v[144:159], v[204:207], v[12:15], v[144:159]
  ds_read_b64_tr_b16 v[188:189], v213 offset:20480
  ds_read_b64_tr_b16 v[190:191], v213 offset:20992
  buffer_load_dwordx4 v216, s[12:15], s55 offen lds
  s_waitcnt lgkmcnt(0)
  v_mfma_f32_32x32x16_bf16 v[128:143], v[176:179], v[16:19], v[128:143]
  ds_read_b128 v[24:27], v210 offset:16384
  ds_read_b64_tr_b16 v[192:193], v212 offset:24576
  ds_read_b64_tr_b16 v[194:195], v212 offset:25088
  ds_read_b64_tr_b16 v[196:197], v213 offset:24576
  buffer_load_dwordx4 v217, s[16:19], s55 offen offset:1024 lds
  v_mfma_f32_32x32x16_bf16 v[144:159], v[180:183], v[16:19], v[144:159]
  ds_read_b64_tr_b16 v[198:199], v213 offset:25088
  ds_read_b128 v[28:31], v211 offset:16384
  ds_read_b64_tr_b16 v[200:201], v212 offset:28672
  ds_read_b64_tr_b16 v[202:203], v212 offset:29184
  s_cmp_lg_u32 s4, 2
  s_cbranch_scc1 L4
  s_lshl_b32 s3, s2, 4
  v_min_u32 v252, 15, v220
  v_add_u32 v252, s3, v252
  v_lshlrev_b32 v252, 7, v252
  s_mov_b32 m0, 151552
  s_nop 0
  global_load_lds_dword v252, s[20:21]
L4:
  v_mfma_f32_32x32x16_bf16 v[128:143], v[184:187], v[20:23], v[128:143]
  ds_read_b64_tr_b16 v[204:205], v213 offset:28672
  ds_read_b64_tr_b16 v[206:207], v213 offset:29184
  s_cmp_lg_u32 s4, 3
  s_cbranch_scc1 L5
  s_lshl_b32 s3, s2, 4
  v_min_u32 v252, 15, v220
  v_add_u32 v252, s3, v252
  v_lshlrev_b32 v252, 7, v252
  s_mov_b32 m0, 151552
  s_nop 0
  global_load_lds_dword v252, s[24:25]
L5:
  v_mfma_f32_32x32x16_bf16 v[144:159], v[188:191], v[20:23], v[144:159]
  s_waitcnt lgkmcnt(0)
  v_mfma_f32_32x32x16_bf16 v[128:143], v[192:195], v[24:27], v[128:143]
  s_waitcnt vmcnt(4) lgkmcnt(0)
  s_barrier
  s_add_u32 m0, s71, 0
  v_mfma_f32_32x32x16_bf16 v[144:159], v[196:199], v[24:27], v[144:159]
  ds_read_b128 v[32:35], v208 offset:32768
  ds_read_b64_tr_b16 v[176:177], v212 offset:32768
  ds_read_b64_tr_b16 v[178:179], v212 offset:33280
  ds_read_b64_tr_b16 v[180:181], v213 offset:32768
  buffer_load_dwordx4 v214, s[8:11], s42 offen lds
  v_mfma_f32_32x32x16_bf16 v[128:143], v[200:203], v[28:31], v[128:143]
  ds_read_b64_tr_b16 v[182:183], v213 offset:33280
  ds_read_b128 v[36:39], v209 offset:32768
  ds_read_b64_tr_b16 v[184:185], v212 offset:36864
  ds_read_b64_tr_b16 v[186:187], v212 offset:37376
  buffer_load_dwordx4 v215, s[8:11], s42 offen offset:1024 lds
  s_add_u32 m0, s71, 65536
  v_mfma_f32_32x32x16_bf16 v[144:159], v[204:207], v[28:31], v[144:159]
  ds_read_b64_tr_b16 v[188:189], v213 offset:36864
  ds_read_b64_tr_b16 v[190:191], v213 offset:37376
  buffer_load_dwordx4 v216, s[12:15], s56 offen lds
  s_waitcnt lgkmcnt(0)
  v_mfma_f32_32x32x16_bf16 v[128:143], v[176:179], v[32:35], v[128:143]
  ds_read_b128 v[40:43], v210 offset:32768
  ds_read_b64_tr_b16 v[192:193], v212 offset:40960
  ds_read_b64_tr_b16 v[194:195], v212 offset:41472
  ds_read_b64_tr_b16 v[196:197], v213 offset:40960
  buffer_load_dwordx4 v217, s[16:19], s56 offen offset:1024 lds
  v_mfma_f32_32x32x16_bf16 v[144:159], v[180:183], v[32:35], v[144:159]
  ds_read_b64_tr_b16 v[198:199], v213 offset:41472
  ds_read_b128 v[44:47], v211 offset:32768
  ds_read_b64_tr_b16 v[200:201], v212 offset:45056
  ds_read_b64_tr_b16 v[202:203], v212 offset:45568
  v_mfma_f32_32x32x16_bf16 v[128:143], v[184:187], v[36:39], v[128:143]
  ds_read_b64_tr_b16 v[204:205], v213 offset:45056
  ds_read_b64_tr_b16 v[206:207], v213 offset:45568
  v_mfma_f32_32x32x16_bf16 v[144:159], v[188:191], v[36:39], v[144:159]
  s_waitcnt lgkmcnt(0)
  v_mfma_f32_32x32x16_bf16 v[128:143], v[192:195], v[40:43], v[128:143]
  s_waitcnt vmcnt(4) lgkmcnt(0)
  s_barrier
  s_add_u32 m0, s71, 16384
  v_mfma_f32_32x32x16_bf16 v[144:159], v[196:199], v[40:43], v[144:159]
  ds_read_b128 v[48:51], v208 offset:49152
  ds_read_b64_tr_b16 v[176:177], v212 offset:49152
  ds_read_b64_tr_b16 v[178:179], v212 offset:49664
  ds_read_b64_tr_b16 v[180:181], v213 offset:49152
  buffer_load_dwordx4 v214, s[8:11], s43 offen lds
  v_mfma_f32_32x32x16_bf16 v[128:143], v[200:203], v[44:47], v[128:143]
  ds_read_b64_tr_b16 v[182:183], v213 offset:49664
  ds_read_b128 v[52:55], v209 offset:49152
  ds_read_b64_tr_b16 v[184:185], v212 offset:53248
  ds_read_b64_tr_b16 v[186:187], v212 offset:53760
  buffer_load_dwordx4 v215, s[8:11], s43 offen offset:1024 lds
  s_add_u32 m0, s71, 81920
  v_mfma_f32_32x32x16_bf16 v[144:159], v[204:207], v[44:47], v[144:159]
  ds_read_b64_tr_b16 v[188:189], v213 offset:53248
  ds_read_b64_tr_b16 v[190:191], v213 offset:53760
  buffer_load_dwordx4 v216, s[12:15], s57 offen lds
  s_waitcnt lgkmcnt(0)
  v_mfma_f32_32x32x16_bf16 v[128:143], v[176:179], v[48:51], v[128:143]
  ds_read_b128 v[56:59], v210 offset:49152
  ds_read_b64_tr_b16 v[192:193], v212 offset:57344
  ds_read_b64_tr_b16 v[194:195], v212 offset:57856
  ds_read_b64_tr_b16 v[196:197], v213 offset:57344
  buffer_load_dwordx4 v217, s[16:19], s57 offen offset:1024 lds
  v_mfma_f32_32x32x16_bf16 v[144:159], v[180:183], v[48:51], v[144:159]
  ds_read_b64_tr_b16 v[198:199], v213 offset:57856
  ds_read_b128 v[60:63], v211 offset:49152
  ds_read_b64_tr_b16 v[200:201], v212 offset:61440
  ds_read_b64_tr_b16 v[202:203], v212 offset:61952
  s_cmp_lg_u32 s4, 0
  s_cbranch_scc1 L6
  s_mul_i32 s3, s2, 28
  v_min_u32 v252, 27, v220
  v_add_u32 v252, s3, v252
  v_lshlrev_b32 v252, 8, v252
  v_add_u32 v252, 128, v252
  s_mov_b32 m0, 151552
  s_nop 0
  global_load_lds_dword v252, s[12:13]
L6:
  v_mfma_f32_32x32x16_bf16 v[128:143], v[184:187], v[52:55], v[128:143]
  ds_read_b64_tr_b16 v[204:205], v213 offset:61440
  ds_read_b64_tr_b16 v[206:207], v213 offset:61952
  s_cmp_lg_u32 s4, 1
  s_cbranch_scc1 L7
  s_mul_i32 s3, s2, 28
  s_add_u32 s3, s3, 4
  v_min_u32 v252, 27, v220
  v_add_u32 v252, s3, v252
  v_lshlrev_b32 v252, 8, v252
  v_add_u32 v252, 128, v252
  s_mov_b32 m0, 151552
  s_nop 0
  global_load_lds_dword v252, s[16:17]
L7:
  v_mfma_f32_32x32x16_bf16 v[144:159], v[188:191], v[52:55], v[144:159]
  s_waitcnt lgkmcnt(0)
  v_mfma_f32_32x32x16_bf16 v[128:143], v[192:195], v[56:59], v[128:143]
  s_waitcnt vmcnt(4) lgkmcnt(0)
  s_barrier
  s_add_u32 m0, s71, 32768
  v_mfma_f32_32x32x16_bf16 v[144:159], v[196:199], v[56:59], v[144:159]
  ds_read_b128 v[64:67], v208 offset:0
  ds_read_b64_tr_b16 v[176:177], v212 offset:0
  ds_read_b64_tr_b16 v[178:179], v212 offset:512
  ds_read_b64_tr_b16 v[180:181], v213 offset:0
  buffer_load_dwordx4 v214, s[8:11], s44 offen lds
  v_mfma_f32_32x32x16_bf16 v[128:143], v[200:203], v[60:63], v[128:143]
  ds_read_b64_tr_b16 v[182:183], v213 offset:512
  ds_read_b128 v[68:71], v209 offset:0
  ds_read_b64_tr_b16 v[184:185], v212 offset:4096
  ds_read_b64_tr_b16 v[186:187], v212 offset:4608
  buffer_load_dwordx4 v215, s[8:11], s44 offen offset:1024 lds
  s_add_u32 m0, s71, 98304
  v_mfma_f32_32x32x16_bf16 v[144:159], v[204:207], v[60:63], v[144:159]
  ds_read_b64_tr_b16 v[188:189], v213 offset:4096
  ds_read_b64_tr_b16 v[190:191], v213 offset:4608
  buffer_load_dwordx4 v216, s[12:15], s58 offen lds
  s_waitcnt lgkmcnt(0)
  v_mfma_f32_32x32x16_bf16 v[128:143], v[176:179], v[64:67], v[128:143]
  ds_read_b128 v[72:75], v210 offset:0
  ds_read_b64_tr_b16 v[192:193], v212 offset:8192
  ds_read_b64_tr_b16 v[194:195], v212 offset:8704
  ds_read_b64_tr_b16 v[196:197], v213 offset:8192
  buffer_load_dwordx4 v217, s[16:19], s58 offen offset:1024 lds
  v_mfma_f32_32x32x16_bf16 v[144:159], v[180:183], v[64:67], v[144:159]
  ds_read_b64_tr_b16 v[198:199], v213 offset:8704
  ds_read_b128 v[76:79], v211 offset:0
  ds_read_b64_tr_b16 v[200:201], v212 offset:12288
  ds_read_b64_tr_b16 v[202:203], v212 offset:12800
  v_mfma_f32_32x32x16_bf16 v[128:143], v[184:187], v[68:71], v[128:143]
  ds_read_b64_tr_b16 v[204:205], v213 offset:12288
  ds_read_b64_tr_b16 v[206:207], v213 offset:12800
  v_mfma_f32_32x32x16_bf16 v[144:159], v[188:191], v[68:71], v[144:159]
  s_waitcnt lgkmcnt(0)
  v_mfma_f32_32x32x16_bf16 v[128:143], v[192:195], v[72:75], v[128:143]
  s_waitcnt vmcnt(4) lgkmcnt(0)
  s_barrier
  s_add_u32 m0, s71, 49152
  v_mfma_f32_32x32x16_bf16 v[144:159], v[196:199], v[72:75], v[144:159]
  ds_read_b128 v[80:83], v208 offset:16384
  ds_read_b64_tr_b16 v[176:177], v212 offset:16384
  ds_read_b64_tr_b16 v[178:179], v212 offset:16896
  ds_read_b64_tr_b16 v[180:181], v213 offset:16384
  buffer_load_dwordx4 v214, s[8:11], s45 offen lds
  v_mfma_f32_32x32x16_bf16 v[128:143], v[200:203], v[76:79], v[128:143]
  ds_read_b64_tr_b16 v[182:183], v213 offset:16896
  ds_read_b128 v[84:87], v209 offset:16384
  ds_read_b64_tr_b16 v[184:185], v212 offset:20480
  ds_read_b64_tr_b16 v[186:187], v212 offset:20992
  buffer_load_dwordx4 v215, s[8:11], s45 offen offset:1024 lds
  s_add_u32 m0, s71, 114688
  v_mfma_f32_32x32x16_bf16 v[144:159], v[204:207], v[76:79], v[144:159]
  ds_read_b64_tr_b16 v[188:189], v213 offset:20480
  ds_read_b64_tr_b16 v[190:191], v213 offset:20992
  buffer_load_dwordx4 v216, s[12:15], s59 offen lds
  s_waitcnt lgkmcnt(0)
  v_mfma_f32_32x32x16_bf16 v[128:143], v[176:179], v[80:83], v[128:143]
  ds_read_b128 v[88:91], v210 offset:16384
  ds_read_b64_tr_b16 v[192:193], v212 offset:24576
  ds_read_b64_tr_b16 v[194:195], v212 offset:25088
  ds_read_b64_tr_b16 v[196:197], v213 offset:24576
  buffer_load_dwordx4 v217, s[16:19], s59 offen offset:1024 lds
  v_mfma_f32_32x32x16_bf16 v[144:159], v[180:183], v[80:83], v[144:159]
  ds_read_b64_tr_b16 v[198:199], v213 offset:25088
  ds_read_b128 v[92:95], v211 offset:16384
  ds_read_b64_tr_b16 v[200:201], v212 offset:28672
  ds_read_b64_tr_b16 v[202:203], v212 offset:29184
  v_mfma_f32_32x32x16_bf16 v[128:143], v[184:187], v[84:87], v[128:143]
  ds_read_b64_tr_b16 v[204:205], v213 offset:28672
  ds_read_b64_tr_b16 v[206:207], v213 offset:29184
  v_mfma_f32_32x32x16_bf16 v[144:159], v[188:191], v[84:87], v[144:159]
  s_waitcnt lgkmcnt(0)
  v_mfma_f32_32x32x16_bf16 v[128:143], v[192:195], v[88:91], v[128:143]
  s_waitcnt vmcnt(4) lgkmcnt(0)
  s_barrier
  v_add_u32 v216, 128, v216
  v_add_u32 v217, 128, v217
  s_add_u32 m0, s73, 0
  v_mfma_f32_32x32x16_bf16 v[144:159], v[196:199], v[88:91], v[144:159]
  ds_read_b128 v[96:99], v208 offset:32768
  ds_read_b64_tr_b16 v[176:177], v212 offset:32768
  ds_read_b64_tr_b16 v[178:179], v212 offset:33280
  ds_read_b64_tr_b16 v[180:181], v213 offset:32768
  buffer_load_dwordx4 v218, s[20:23], s98 offen lds
  s_add_u32 m0, s73, 4096
  v_mfma_f32_32x32x16_bf16 v[128:143], v[200:203], v[92:95], v[128:143]
  ds_read_b64_tr_b16 v[182:183], v213 offset:33280
  ds_read_b128 v[100:103], v209 offset:32768
  ds_read_b64_tr_b16 v[184:185], v212 offset:36864
  ds_read_b64_tr_b16 v[186:187], v212 offset:37376
  buffer_load_dwordx4 v218, s[20:23], s99 offen lds
  s_add_u32 m0, s73, 65536
  v_mfma_f32_32x32x16_bf16 v[144:159], v[204:207], v[92:95], v[144:159]
  ds_read_b64_tr_b16 v[188:189], v213 offset:36864
  ds_read_b64_tr_b16 v[190:191], v213 offset:37376
  buffer_load_dwordx4 v218, s[24:27], s98 offen lds
  s_waitcnt lgkmcnt(0)
  s_add_u32 m0, s73, 69632
  v_mfma_f32_32x32x16_bf16 v[128:143], v[176:179], v[96:99], v[128:143]
  ds_read_b128 v[104:107], v210 offset:32768
  ds_read_b64_tr_b16 v[192:193], v212 offset:40960
  ds_read_b64_tr_b16 v[194:195], v212 offset:41472
  ds_read_b64_tr_b16 v[196:197], v213 offset:40960
  buffer_load_dwordx4 v218, s[24:27], s99 offen lds
  v_mfma_f32_32x32x16_bf16 v[144:159], v[180:183], v[96:99], v[144:159]
  ds_read_b64_tr_b16 v[198:199], v213 offset:41472
  ds_read_b128 v[108:111], v211 offset:32768
  ds_read_b64_tr_b16 v[200:201], v212 offset:45056
  ds_read_b64_tr_b16 v[202:203], v212 offset:45568
  v_mfma_f32_32x32x16_bf16 v[128:143], v[184:187], v[100:103], v[128:143]
  ds_read_b64_tr_b16 v[204:205], v213 offset:45056
  ds_read_b64_tr_b16 v[206:207], v213 offset:45568
  v_mfma_f32_32x32x16_bf16 v[144:159], v[188:191], v[100:103], v[144:159]
  s_waitcnt lgkmcnt(0)
  v_mfma_f32_32x32x16_bf16 v[128:143], v[192:195], v[104:107], v[128:143]
  s_waitcnt vmcnt(4) lgkmcnt(0)
  s_barrier
  s_add_u32 m0, s73, 16384
  v_mfma_f32_32x32x16_bf16 v[144:159], v[196:199], v[104:107], v[144:159]
  ds_read_b128 v[112:115], v208 offset:49152
  ds_read_b64_tr_b16 v[176:177], v212 offset:49152
  ds_read_b64_tr_b16 v[178:179], v212 offset:49664
  ds_read_b64_tr_b16 v[180:181], v213 offset:49152
  buffer_load_dwordx4 v218, s[20:23], s100 offen lds
  s_add_u32 m0, s73, 20480
  v_mfma_f32_32x32x16_bf16 v[128:143], v[200:203], v[108:111], v[128:143]
  ds_read_b64_tr_b16 v[182:183], v213 offset:49664
  ds_read_b128 v[116:119], v209 offset:49152
  ds_read_b64_tr_b16 v[184:185], v212 offset:53248
  ds_read_b64_tr_b16 v[186:187], v212 offset:53760
  buffer_load_dwordx4 v218, s[20:23], s101 offen lds
  s_add_u32 m0, s73, 81920
  v_mfma_f32_32x32x16_bf16 v[144:159], v[204:207], v[108:111], v[144:159]
  ds_read_b64_tr_b16 v[188:189], v213 offset:53248
  ds_read_b64_tr_b16 v[190:191], v213 offset:53760
  buffer_load_dwordx4 v218, s[24:27], s100 offen lds
  s_waitcnt lgkmcnt(0)
  s_add_u32 m0, s73, 86016
  v_mfma_f32_32x32x16_bf16 v[128:143], v[176:179], v[112:115], v[128:143]
  ds_read_b128 v[120:123], v210 offset:49152
  ds_read_b64_tr_b16 v[192:193], v212 offset:57344
  ds_read_b64_tr_b16 v[194:195], v212 offset:57856
  ds_read_b64_tr_b16 v[196:197], v213 offset:57344
  buffer_load_dwordx4 v218, s[24:27], s101 offen lds
  v_mfma_f32_32x32x16_bf16 v[144:159], v[180:183], v[112:115], v[144:159]
  ds_read_b64_tr_b16 v[198:199], v213 offset:57856
  ds_read_b128 v[124:127], v211 offset:49152
  ds_read_b64_tr_b16 v[200:201], v212 offset:61440
  ds_read_b64_tr_b16 v[202:203], v212 offset:61952
  s_cmp_lg_u32 s4, 4
  s_cbranch_scc1 L8
  s_mul_i32 s3, s2, 28
  v_min_u32 v252, 27, v220
  v_add_u32 v252, s3, v252
  v_lshrrev_b32 v254, 9, v252
  v_lshl_add_u32 v252, v254, 9, v252
  v_add_u32 v252, 0, v252
  v_lshlrev_b32 v252, 7, v252
  s_mov_b32 m0, 151552
  s_nop 0
  global_load_lds_dword v252, s[60:61]
L8:
  v_mfma_f32_32x32x16_bf16 v[128:143], v[184:187], v[116:119], v[128:143]
  ds_read_b64_tr_b16 v[204:205], v213 offset:61440
  ds_read_b64_tr_b16 v[206:207], v213 offset:61952
  v_mfma_f32_32x32x16_bf16 v[144:159], v[188:191], v[116:119], v[144:159]
  s_waitcnt lgkmcnt(0)
  v_mfma_f32_32x32x16_bf16 v[128:143], v[192:195], v[120:123], v[128:143]
  s_waitcnt vmcnt(4) lgkmcnt(0)
  s_barrier
  v_and_b32 v250, 15, v220
  v_lshrrev_b32 v251, 5, v220
  v_lshrrev_b32 v208, 1, v250
  v_xor_b32 v251, v251, v208
  s_lshl_b32 s3, s70, 11
  v_lshl_add_u32 v250, v250, 7, s3
  v_lshl_add_u32 v250, v251, 4, v250
  v_bfe_u32 v251, v220, 4, 1
  v_lshl_add_u32 v208, v251, 16, v250
  v_xor_b32 v209, 32, v208
  v_xor_b32 v210, 64, v208
  v_xor_b32 v211, 96, v208
  v_mul_u32_u24 v251, 64512, v251
  v_subrev_u32 v251, 0x10000, v251
  v_lshrrev_b32 v250, 5, v220
  v_lshlrev_b32 v250, 10, v250
  v_sub_u32 v251, v251, v250
  v_add_u32 v212, v212, v251
  v_add_u32 v213, v213, v251
  s_add_u32 m0, s72, 32768
  v_mfma_f32_32x32x16_bf16 v[144:159], v[196:199], v[120:123], v[144:159]
  ds_read_b128 v[176:179], v208 offset:0
  ds_read_b128 v[180:183], v209 offset:0
  ds_read_b128 v[184:187], v210 offset:0
  ds_read_b128 v[188:191], v211 offset:0
  buffer_load_dwordx4 v216, s[12:15], s50 offen lds
  s_add_u32 m0, s72, 97280
  v_mfma_f32_32x32x16_bf16 v[128:143], v[200:203], v[124:127], v[128:143]
  buffer_load_dwordx4 v217, s[16:19], s50 offen offset:1024 lds
  s_add_u32 m0, s72, 40960
  v_mfma_f32_32x32x16_bf16 v[144:159], v[204:207], v[124:127], v[144:159]
  buffer_load_dwordx4 v216, s[12:15], s51 offen lds
  s_waitcnt lgkmcnt(0)
  s_add_u32 m0, s72, 105472
  v_mfma_f32_32x32x16_bf16 v[160:175], v[0:3], v[176:179], 0
  ds_read_b128 v[192:195], v208 offset:4096
  ds_read_b128 v[196:199], v209 offset:4096
  ds_read_b128 v[200:203], v210 offset:4096
  ds_read_b128 v[204:207], v211 offset:4096
  buffer_load_dwordx4 v217, s[16:19], s51 offen offset:1024 lds
  v_mfma_f32_32x32x16_bf16 v[160:175], v[4:7], v[180:183], v[160:175]
  s_cmp_lg_u32 s4, 5
  s_cbranch_scc1 L9
  s_mul_i32 s3, s2, 28
  v_min_u32 v252, 27, v220
  v_add_u32 v252, s3, v252
  v_lshrrev_b32 v254, 9, v252
  v_lshl_add_u32 v252, v254, 9, v252
  v_add_u32 v252, 512, v252
  v_lshlrev_b32 v252, 7, v252
  s_mov_b32 m0, 151552
  s_nop 0
  global_load_lds_dword v252, s[60:61]
L9:
  v_mfma_f32_32x32x16_bf16 v[160:175], v[8:11], v[184:187], v[160:175]
  v_mfma_f32_32x32x16_bf16 v[160:175], v[12:15], v[188:191], v[160:175]
  s_waitcnt lgkmcnt(0)
  v_mfma_f32_32x32x16_bf16 v[160:175], v[16:19], v[192:195], v[160:175]
  ds_read_b128 v[176:179], v208 offset:8192
  ds_read_b128 v[180:183], v209 offset:8192
  ds_read_b128 v[184:187], v210 offset:8192
  ds_read_b128 v[188:191], v211 offset:8192
  v_mul_f32 v136, v128, v136
  v_mul_f32 v137, v129, v137
  v_mul_f32 v138, v130, v138
  v_mul_f32 v139, v131, v139
  v_mul_f32 v140, v132, v140
  v_mfma_f32_32x32x16_bf16 v[160:175], v[20:23], v[196:199], v[160:175]
  v_mul_f32 v141, v133, v141
  v_mul_f32 v142, v134, v142
  v_mul_f32 v143, v135, v143
  v_mul_f32 v128, 0xbfb8aa3b, v128
  v_mul_f32 v129, 0xbfb8aa3b, v129
  v_mfma_f32_32x32x16_bf16 v[160:175], v[24:27], v[200:203], v[160:175]
  v_mul_f32 v130, 0xbfb8aa3b, v130
  v_mul_f32 v131, 0xbfb8aa3b, v131
  v_mul_f32 v132, 0xbfb8aa3b, v132
  v_mul_f32 v133, 0xbfb8aa3b, v133
  v_mul_f32 v134, 0xbfb8aa3b, v134
  v_mfma_f32_32x32x16_bf16 v[160:175], v[28:31], v[204:207], v[160:175]
  v_mul_f32 v135, 0xbfb8aa3b, v135
  v_exp_f32 v128, v128
  v_exp_f32 v129, v129
  v_exp_f32 v130, v130
  v_exp_f32 v131, v131
  s_waitcnt lgkmcnt(0)
  v_mfma_f32_32x32x16_bf16 v[160:175], v[32:35], v[176:179], v[160:175]
  ds_read_b128 v[192:195], v208 offset:12288
  ds_read_b128 v[196:199], v209 offset:12288
  ds_read_b128 v[200:203], v210 offset:12288
  ds_read_b128 v[204:207], v211 offset:12288
  v_exp_f32 v132, v132
  v_exp_f32 v133, v133
  v_exp_f32 v134, v134
  v_exp_f32 v135, v135
  v_add_f32 v128, 1.0, v128
  v_mfma_f32_32x32x16_bf16 v[160:175], v[36:39], v[180:183], v[160:175]
  v_add_f32 v129, 1.0, v129
  v_add_f32 v130, 1.0, v130
  v_add_f32 v131, 1.0, v131
  v_add_f32 v132, 1.0, v132
  v_add_f32 v133, 1.0, v133
  v_mfma_f32_32x32x16_bf16 v[160:175], v[40:43], v[184:187], v[160:175]
  v_add_f32 v134, 1.0, v134
  v_add_f32 v135, 1.0, v135
  v_rcp_f32 v128, v128
  v_rcp_f32 v129, v129
  v_rcp_f32 v130, v130
  v_mfma_f32_32x32x16_bf16 v[160:175], v[44:47], v[188:191], v[160:175]
  v_rcp_f32 v131, v131
  v_rcp_f32 v132, v132
  v_rcp_f32 v133, v133
  v_rcp_f32 v134, v134
  v_rcp_f32 v135, v135
  s_waitcnt lgkmcnt(0)
  v_mfma_f32_32x32x16_bf16 v[160:175], v[48:51], v[192:195], v[160:175]
  v_mul_f32 v136, v128, v136
  v_mul_f32 v137, v129, v137
  v_mul_f32 v138, v130, v138
  v_mul_f32 v139, v131, v139
  v_mul_f32 v140, v132, v140
  s_waitcnt vmcnt(4) lgkmcnt(0)
  s_barrier
  s_add_u32 m0, s72, 49152
  v_mfma_f32_32x32x16_bf16 v[160:175], v[52:55], v[196:199], v[160:175]
  ds_read_b128 v[176:179], v208 offset:16384
  ds_read_b128 v[180:183], v209 offset:16384
  ds_read_b128 v[184:187], v210 offset:16384
  ds_read_b128 v[188:191], v211 offset:16384
  buffer_load_dwordx4 v216, s[12:15], s54 offen lds
  s_add_u32 m0, s72, 113664
  v_mfma_f32_32x32x16_bf16 v[160:175], v[56:59], v[200:203], v[160:175]
  buffer_load_dwordx4 v217, s[16:19], s54 offen offset:1024 lds
  s_add_u32 m0, s72, 57344
  v_mfma_f32_32x32x16_bf16 v[160:175], v[60:63], v[204:207], v[160:175]
  buffer_load_dwordx4 v216, s[12:15], s55 offen lds
  s_waitcnt lgkmcnt(0)
  v_and_b32 v215, 15, v220
  v_lshlrev_b32 v215, 2, v215
  global_load_dword v214, v215, s[66:67] sc1
  s_add_u32 m0, s72, 121856
  v_mfma_f32_32x32x16_bf16 v[160:175], v[64:67], v[176:179], v[160:175]
  ds_read_b128 v[192:195], v208 offset:20480
  ds_read_b128 v[196:199], v209 offset:20480
  ds_read_b128 v[200:203], v210 offset:20480
  ds_read_b128 v[204:207], v211 offset:20480
  buffer_load_dwordx4 v217, s[16:19], s55 offen offset:1024 lds
  v_mfma_f32_32x32x16_bf16 v[160:175], v[68:71], v[180:183], v[160:175]
  s_cmp_lg_u32 s4, 6
  s_cbranch_scc1 L10
  s_lshl_b32 s3, s2, 4
  v_min_u32 v252, 15, v220
  v_add_u32 v252, s3, v252
  v_lshlrev_b32 v252, 7, v252
  s_mov_b32 m0, 151552
  s_nop 0
  global_load_lds_dword v252, s[46:47]
L10:
  v_mfma_f32_32x32x16_bf16 v[160:175], v[72:75], v[184:187], v[160:175]
  s_cmp_lg_u32 s4, 7
  s_cbranch_scc1 L11
  s_lshl_b32 s3, s2, 4
  v_min_u32 v252, 15, v220
  v_add_u32 v252, s3, v252
  v_lshlrev_b32 v252, 7, v252
  s_mov_b32 m0, 151552
  s_nop 0
  global_load_lds_dword v252, s[48:49]
L11:
  v_mul_f32 v141, v133, v141
  v_mul_f32 v142, v134, v142
  v_mul_f32 v143, v135, v143
  v_cvt_pk_bf16_f32 v128, v136, v137
  v_cvt_pk_bf16_f32 v129, v138, v139
  v_cvt_pk_bf16_f32 v130, v140, v141
  v_mfma_f32_32x32x16_bf16 v[160:175], v[76:79], v[188:191], v[160:175]
  v_cvt_pk_bf16_f32 v131, v142, v143
  s_add_u32 s74, s75, 0
  buffer_store_dwordx4 v[128:131], v219, s[32:35], s74 offen sc1
  v_mul_f32 v152, v144, v152
  v_mul_f32 v153, v145, v153
  v_mul_f32 v154, v146, v154
  v_mul_f32 v155, v147, v155
  s_waitcnt lgkmcnt(0)
  v_mfma_f32_32x32x16_bf16 v[160:175], v[80:83], v[192:195], v[160:175]
  ds_read_b128 v[176:179], v208 offset:24576
  ds_read_b128 v[180:183], v209 offset:24576
  ds_read_b128 v[184:187], v210 offset:24576
  ds_read_b128 v[188:191], v211 offset:24576
  v_mul_f32 v156, v148, v156
  v_mul_f32 v157, v149, v157
  v_mul_f32 v158, v150, v158
  v_mul_f32 v159, v151, v159
  v_mul_f32 v144, 0xbfb8aa3b, v144
  v_mul_f32 v145, 0xbfb8aa3b, v145
  v_mfma_f32_32x32x16_bf16 v[160:175], v[84:87], v[196:199], v[160:175]
  v_mul_f32 v146, 0xbfb8aa3b, v146
  v_mul_f32 v147, 0xbfb8aa3b, v147
  v_mul_f32 v148, 0xbfb8aa3b, v148
  v_mul_f32 v149, 0xbfb8aa3b, v149
  v_mul_f32 v150, 0xbfb8aa3b, v150
  v_mul_f32 v151, 0xbfb8aa3b, v151
  v_mfma_f32_32x32x16_bf16 v[160:175], v[88:91], v[200:203], v[160:175]
  v_exp_f32 v144, v144
  v_exp_f32 v145, v145
  v_exp_f32 v146, v146
  v_exp_f32 v147, v147
  v_exp_f32 v148, v148
  v_exp_f32 v149, v149
  v_mfma_f32_32x32x16_bf16 v[160:175], v[92:95], v[204:207], v[160:175]
  v_exp_f32 v150, v150
  v_exp_f32 v151, v151
  v_add_f32 v144, 1.0, v144
  v_add_f32 v145, 1.0, v145
  v_add_f32 v146, 1.0, v146
  v_add_f32 v147, 1.0, v147
  s_waitcnt lgkmcnt(0)
  v_mfma_f32_32x32x16_bf16 v[160:175], v[96:99], v[176:179], v[160:175]
  ds_read_b128 v[192:195], v208 offset:28672
  ds_read_b128 v[196:199], v209 offset:28672
  ds_read_b128 v[200:203], v210 offset:28672
  ds_read_b128 v[204:207], v211 offset:28672
  v_add_f32 v148, 1.0, v148
  v_add_f32 v149, 1.0, v149
  v_add_f32 v150, 1.0, v150
  v_add_f32 v151, 1.0, v151
  v_rcp_f32 v144, v144
  v_rcp_f32 v145, v145
  v_mfma_f32_32x32x16_bf16 v[160:175], v[100:103], v[180:183], v[160:175]
  v_rcp_f32 v146, v146
  v_rcp_f32 v147, v147
  v_rcp_f32 v148, v148
  v_rcp_f32 v149, v149
  v_rcp_f32 v150, v150
  v_rcp_f32 v151, v151
  v_mfma_f32_32x32x16_bf16 v[160:175], v[104:107], v[184:187], v[160:175]
  v_mul_f32 v152, v144, v152
  v_mul_f32 v153, v145, v153
  v_mul_f32 v154, v146, v154
  v_mul_f32 v155, v147, v155
  v_mul_f32 v156, v148, v156
  v_mul_f32 v157, v149, v157
  v_mfma_f32_32x32x16_bf16 v[160:175], v[108:111], v[188:191], v[160:175]
  v_mul_f32 v158, v150, v158
  v_mul_f32 v159, v151, v159
  v_cvt_pk_bf16_f32 v144, v152, v153
  v_cvt_pk_bf16_f32 v145, v154, v155
  v_cvt_pk_bf16_f32 v146, v156, v157
  v_cvt_pk_bf16_f32 v147, v158, v159
  s_waitcnt lgkmcnt(0)
  v_mfma_f32_32x32x16_bf16 v[160:175], v[112:115], v[192:195], v[160:175]
  s_add_u32 s74, s75, 1024
  buffer_store_dwordx4 v[144:147], v219, s[32:35], s74 offen sc1
  s_waitcnt vmcnt(7) lgkmcnt(0)
  s_barrier
  s_add_u32 m0, s72, 0
  v_mfma_f32_32x32x16_bf16 v[160:175], v[116:119], v[196:199], v[160:175]
  ds_read_b64_tr_b16 v[176:177], v212 offset:32768
  ds_read_b64_tr_b16 v[178:179], v212 offset:33280
  ds_read_b64_tr_b16 v[180:181], v213 offset:32768
  ds_read_b64_tr_b16 v[182:183], v213 offset:33280
  buffer_load_dwordx4 v216, s[12:15], s56 offen lds
  s_add_u32 m0, s72, 64512
  v_mfma_f32_32x32x16_bf16 v[160:175], v[120:123], v[200:203], v[160:175]
  ds_read_b64_tr_b16 v[184:185], v212 offset:34816
  ds_read_b64_tr_b16 v[186:187], v212 offset:35328
  ds_read_b64_tr_b16 v[188:189], v213 offset:34816
  ds_read_b64_tr_b16 v[190:191], v213 offset:35328
  buffer_load_dwordx4 v217, s[16:19], s56 offen offset:1024 lds
  s_add_u32 m0, s72, 8192
  v_mfma_f32_32x32x16_bf16 v[160:175], v[124:127], v[204:207], v[160:175]
  buffer_load_dwordx4 v216, s[12:15], s57 offen lds
  s_waitcnt lgkmcnt(0)
  s_and_b32 s98, s2, 7
  s_lshl_b32 s98, s98, 2
  s_lshr_b32 s3, s2, 6
  s_add_u32 s98, s98, s3
  s_bfe_u32 s99, s2, 0x30003
  s_lshl_b32 s3, s3, 1
  s_add_u32 s3, s3, s99
  s_cmp_ge_u32 s3, 7
  s_cselect_b32 s74, 7, 0
  s_sub_u32 s3, s3, s74
  s_lshl_b32 s38, s3, 13
  s_add_u32 s3, s38, 8192
  s_cmp_ge_u32 s3, 57344
  s_cselect_b32 s39, 0, s3
  s_add_u32 s3, s39, 8192
  s_cmp_ge_u32 s3, 57344
  s_cselect_b32 s40, 0, s3
  s_add_u32 s3, s40, 8192
  s_cmp_ge_u32 s3, 57344
  s_cselect_b32 s41, 0, s3
  s_add_u32 s3, s41, 8192
  s_cmp_ge_u32 s3, 57344
  s_cselect_b32 s42, 0, s3
  s_add_u32 s3, s42, 8192
  s_cmp_ge_u32 s3, 57344
  s_cselect_b32 s43, 0, s3
  s_add_u32 s3, s43, 8192
  s_cmp_ge_u32 s3, 57344
  s_cselect_b32 s44, 0, s3
  s_mul_i32 s3, s70, 56
  s_add_u32 s3, s3, s7
  s_lshl_b32 s96, s3, 14
  s_add_u32 s97, s96, 65536
  s_lshl_b32 s3, s3, 10
  s_mul_i32 s73, s98, 360448
  s_add_u32 s100, s73, s3
  s_add_u32 s101, s100, 4096
  s_lshr_b32 s45, s98, 1
  s_lshl_b32 s45, s45, 13
  s_add_u32 s45, s45, 12718080
  s_mov_b32 s8, s60
  s_mov_b32 s9, s61
  s_mov_b32 s10, 1835008
  s_mov_b32 s11, 0x20000
  v_lshrrev_b32 v254, 3, v220
  v_and_b32 v252, 2, v254
  v_lshlrev_b32 v252, 1, v252
  v_xor_b32 v252, v252, v220
  v_and_b32 v252, 7, v252
  s_lshl_b32 s3, s99, 7
  v_lshl_add_u32 v252, v252, 4, s3
  v_lshl_add_u32 v218, v254, 10, v252
  v_add_u32 v253, 7168, v218
  s_add_u32 m0, s72, 72704
  v_mfma_f32_32x32x16_bf16 v[128:143], v[176:179], v[0:3], 0
  ds_read_b64_tr_b16 v[192:193], v212 offset:36864
  ds_read_b64_tr_b16 v[194:195], v212 offset:37376
  ds_read_b64_tr_b16 v[196:197], v213 offset:36864
  ds_read_b64_tr_b16 v[198:199], v213 offset:37376
  buffer_load_dwordx4 v217, s[16:19], s57 offen offset:1024 lds
  v_mfma_f32_32x32x16_bf16 v[144:159], v[180:183], v[0:3], 0
  ds_read_b64_tr_b16 v[200:201], v212 offset:38912
  ds_read_b64_tr_b16 v[202:203], v212 offset:39424
  ds_read_b64_tr_b16 v[204:205], v213 offset:38912
  ds_read_b64_tr_b16 v[206:207], v213 offset:39424
  v_mfma_f32_32x32x16_bf16 v[128:143], v[184:187], v[4:7], v[128:143]
  v_mfma_f32_32x32x16_bf16 v[144:159], v[188:191], v[4:7], v[144:159]
  s_waitcnt lgkmcnt(0)
  v_mfma_f32_32x32x16_bf16 v[128:143], v[192:195], v[8:11], v[128:143]
  ds_read_b64_tr_b16 v[176:177], v212 offset:40960
  ds_read_b64_tr_b16 v[178:179], v212 offset:41472
  ds_read_b64_tr_b16 v[180:181], v213 offset:40960
  ds_read_b64_tr_b16 v[182:183], v213 offset:41472
  v_permlane16_swap_b32 v160, v168
  v_permlane16_swap_b32 v161, v169
  v_permlane16_swap_b32 v162, v170
  v_permlane16_swap_b32 v163, v171
  v_permlane16_swap_b32 v164, v172
  v_mfma_f32_32x32x16_bf16 v[144:159], v[196:199], v[8:11], v[144:159]
  ds_read_b64_tr_b16 v[184:185], v212 offset:43008
  ds_read_b64_tr_b16 v[186:187], v212 offset:43520
  ds_read_b64_tr_b16 v[188:189], v213 offset:43008
  ds_read_b64_tr_b16 v[190:191], v213 offset:43520
  v_permlane16_swap_b32 v165, v173
  v_permlane16_swap_b32 v166, v174
  v_permlane16_swap_b32 v167, v175
  v_mul_f32 v242, v241, v168
  v_mul_f32 v243, v241, v160
  v_mfma_f32_32x32x16_bf16 v[128:143], v[200:203], v[12:15], v[128:143]
  v_fma_f32 v160, v240, v160, -v242
  v_fma_f32 v168, v240, v168, v243
  v_mul_f32 v244, v241, v169
  v_mul_f32 v245, v241, v161
  v_fma_f32 v161, v240, v161, -v244
  v_mfma_f32_32x32x16_bf16 v[144:159], v[204:207], v[12:15], v[144:159]
  v_fma_f32 v169, v240, v169, v245
  v_mul_f32 v242, v241, v170
  v_mul_f32 v243, v241, v162
  v_fma_f32 v162, v240, v162, -v242
  v_fma_f32 v170, v240, v170, v243
  s_waitcnt lgkmcnt(0)
  v_mfma_f32_32x32x16_bf16 v[128:143], v[176:179], v[16:19], v[128:143]
  ds_read_b64_tr_b16 v[192:193], v212 offset:45056
  ds_read_b64_tr_b16 v[194:195], v212 offset:45568
  ds_read_b64_tr_b16 v[196:197], v213 offset:45056
  ds_read_b64_tr_b16 v[198:199], v213 offset:45568
  v_mul_f32 v244, v241, v171
  v_mul_f32 v245, v241, v163
  v_fma_f32 v163, v240, v163, -v244
  v_fma_f32 v171, v240, v171, v245
  v_mul_f32 v242, v241, v172
  v_mfma_f32_32x32x16_bf16 v[144:159], v[180:183], v[16:19], v[144:159]
  ds_read_b64_tr_b16 v[200:201], v212 offset:47104
  ds_read_b64_tr_b16 v[202:203], v212 offset:47616
  ds_read_b64_tr_b16 v[204:205], v213 offset:47104
  ds_read_b64_tr_b16 v[206:207], v213 offset:47616
  v_mul_f32 v243, v241, v164
  v_fma_f32 v164, v240, v164, -v242
  v_fma_f32 v172, v240, v172, v243
  v_mul_f32 v244, v241, v173
  v_mul_f32 v245, v241, v165
  v_mfma_f32_32x32x16_bf16 v[128:143], v[184:187], v[20:23], v[128:143]
  v_fma_f32 v165, v240, v165, -v244
  v_fma_f32 v173, v240, v173, v245
  v_mul_f32 v242, v241, v174
  v_mul_f32 v243, v241, v166
  v_fma_f32 v166, v240, v166, -v242
  v_mfma_f32_32x32x16_bf16 v[144:159], v[188:191], v[20:23], v[144:159]
  v_fma_f32 v174, v240, v174, v243
  v_mul_f32 v244, v241, v175
  v_mul_f32 v245, v241, v167
  v_fma_f32 v167, v240, v167, -v244
  v_fma_f32 v175, v240, v175, v245
  s_waitcnt lgkmcnt(0)
  v_mfma_f32_32x32x16_bf16 v[128:143], v[192:195], v[24:27], v[128:143]
  v_fma_f32 v244, v222, v160, v161
  v_fma_f32 v245, v222, v168, v169
  v_fma_f32 v244, -v223, v168, v244
  v_fmac_f32 v245, v223, v160
  v_fma_f32 v242, v222, v244, v162
  s_waitcnt vmcnt(7)
  s_mov_b32 s94, 0
L13:
  v_cmp_eq_u32 vcc, 0, v214
  s_add_u32 s94, s94, 1
  s_nop 2
  s_and_b32 s3, vcc_lo, 0xffff
  s_cbranch_scc0 L12
  s_cmp_ge_u32 s94, 0x8000
  s_cbranch_scc1 L12
  s_sleep 2
  global_load_dword v214, v215, s[66:67] sc1
  s_waitcnt vmcnt(0)
  s_branch L13
L12:
  s_waitcnt vmcnt(4)
  s_waitcnt lgkmcnt(0)
  s_barrier
  s_cmp_lg_u32 s4, 0
  s_cbranch_scc1 L14
  s_lshl_b32 s3, s5, 11
  s_add_u32 s3, s3, s6
  s_lshl_b32 s3, s3, 2
  s_add_u32 s3, s3, 12718080
  v_mov_b32 v254, 1
  s_mov_b64 exec, 1
  buffer_store_dword v254, off, s[28:31], s3 sc1
  s_mov_b64 exec, -1
L14:
  v_add_u32 v214, 180224, v219
  v_lshrrev_b32 v252, 5, v220
  v_bfe_u32 v254, v220, 2, 2
  v_lshl_add_u32 v252, v252, 2, v254
  v_lshl_add_u32 v252, v252, 7, s71
  v_bfe_u32 v254, v220, 3, 1
  v_lshl_add_u32 v252, v254, 6, v252
  v_bfe_u32 v254, v220, 4, 1
  v_lshl_add_u32 v252, v254, 5, v252
  v_and_b32 v254, 3, v220
  v_lshl_add_u32 v215, v254, 3, v252
  s_add_u32 m0, s72, 16384
  v_mfma_f32_32x32x16_bf16 v[144:159], v[196:199], v[24:27], v[144:159]
  ds_read_b64_tr_b16 v[176:177], v212 offset:49152
  ds_read_b64_tr_b16 v[178:179], v212 offset:49664
  ds_read_b64_tr_b16 v[180:181], v213 offset:49152
  ds_read_b64_tr_b16 v[182:183], v213 offset:49664
  buffer_load_dwordx4 v216, s[12:15], s58 offen lds
  s_add_u32 m0, s72, 80896
  v_mfma_f32_32x32x16_bf16 v[128:143], v[200:203], v[28:31], v[128:143]
  ds_read_b64_tr_b16 v[184:185], v212 offset:51200
  ds_read_b64_tr_b16 v[186:187], v212 offset:51712
  ds_read_b64_tr_b16 v[188:189], v213 offset:51200
  ds_read_b64_tr_b16 v[190:191], v213 offset:51712
  buffer_load_dwordx4 v217, s[16:19], s58 offen offset:1024 lds
  s_add_u32 m0, s72, 24576
  v_mfma_f32_32x32x16_bf16 v[144:159], v[204:207], v[28:31], v[144:159]
  buffer_load_dwordx4 v216, s[12:15], s59 offen lds
  s_waitcnt lgkmcnt(0)
  s_add_u32 m0, s72, 89088
  v_mfma_f32_32x32x16_bf16 v[128:143], v[176:179], v[32:35], v[128:143]
  ds_read_b64_tr_b16 v[192:193], v212 offset:53248
  ds_read_b64_tr_b16 v[194:195], v212 offset:53760
  ds_read_b64_tr_b16 v[196:197], v213 offset:53248
  ds_read_b64_tr_b16 v[198:199], v213 offset:53760
  buffer_load_dwordx4 v217, s[16:19], s59 offen offset:1024 lds
  v_fma_f32 v243, v222, v245, v170
  v_fma_f32 v242, -v223, v245, v242
  v_fmac_f32 v243, v223, v244
  v_fma_f32 v244, v222, v242, v163
  v_fma_f32 v245, v222, v243, v171
  s_add_u32 m0, s71, 32768
  s_lshl4_add_u32 s74, s38, s96
  v_mfma_f32_32x32x16_bf16 v[144:159], v[180:183], v[32:35], v[144:159]
  ds_read_b64_tr_b16 v[200:201], v212 offset:55296
  ds_read_b64_tr_b16 v[202:203], v212 offset:55808
  ds_read_b64_tr_b16 v[204:205], v213 offset:55296
  ds_read_b64_tr_b16 v[206:207], v213 offset:55808
  buffer_load_dwordx4 v218, s[8:11], s74 offen lds
  v_fma_f32 v244, -v223, v243, v244
  v_fmac_f32 v245, v223, v242
  v_fma_f32 v242, v222, v244, v164
  v_fma_f32 v243, v222, v245, v172
  v_fma_f32 v242, -v223, v245, v242
  s_lshl4_add_u32 s74, s38, s96
  v_mfma_f32_32x32x16_bf16 v[128:143], v[184:187], v[36:39], v[128:143]
  buffer_load_dwordx4 v253, s[8:11], s74 offen offset:1024 lds
  v_fmac_f32 v243, v223, v244
  v_fma_f32 v244, v222, v242, v165
  v_fma_f32 v245, v222, v243, v173
  v_fma_f32 v244, -v223, v243, v244
  v_fmac_f32 v245, v223, v242
  s_add_u32 m0, s71, 98304
  s_lshl4_add_u32 s74, s39, s96
  v_mfma_f32_32x32x16_bf16 v[144:159], v[188:191], v[36:39], v[144:159]
  buffer_load_dwordx4 v218, s[8:11], s74 offen lds
  v_fma_f32 v242, v222, v244, v166
  v_fma_f32 v243, v222, v245, v174
  v_fma_f32 v242, -v223, v245, v242
  v_fmac_f32 v243, v223, v244
  v_fma_f32 v244, v222, v242, v167
  s_waitcnt lgkmcnt(0)
  s_lshl4_add_u32 s74, s39, s96
  v_mfma_f32_32x32x16_bf16 v[128:143], v[192:195], v[40:43], v[128:143]
  ds_read_b64_tr_b16 v[176:177], v212 offset:57344
  ds_read_b64_tr_b16 v[178:179], v212 offset:57856
  ds_read_b64_tr_b16 v[180:181], v213 offset:57344
  ds_read_b64_tr_b16 v[182:183], v213 offset:57856
  buffer_load_dwordx4 v253, s[8:11], s74 offen offset:1024 lds
  v_fma_f32 v245, v222, v243, v175
  v_fma_f32 v244, -v223, v243, v244
  v_fmac_f32 v245, v223, v242
  v_mov_b32 v246, v244
  v_mov_b32 v247, v245
  v_mfma_f32_32x32x16_bf16 v[144:159], v[196:199], v[40:43], v[144:159]
  ds_read_b64_tr_b16 v[184:185], v212 offset:59392
  ds_read_b64_tr_b16 v[186:187], v212 offset:59904
  ds_read_b64_tr_b16 v[188:189], v213 offset:59392
  ds_read_b64_tr_b16 v[190:191], v213 offset:59904
  s_nop 1
  v_permlane16_swap_b32 v246, v244
  v_permlane16_swap_b32 v247, v245
  s_nop 0
  v_fmac_f32 v244, v224, v246
  v_mfma_f32_32x32x16_bf16 v[128:143], v[200:203], v[44:47], v[128:143]
  v_fmac_f32 v245, v224, v247
  v_fma_f32 v244, -v225, v247, v244
  v_fmac_f32 v245, v225, v246
  v_mov_b32 v248, v244
  v_mov_b32 v249, v245
  v_mfma_f32_32x32x16_bf16 v[144:159], v[204:207], v[44:47], v[144:159]
  s_nop 1
  v_permlane32_swap_b32 v248, v244
  v_permlane32_swap_b32 v249, v245
  s_nop 0
  v_fmac_f32 v244, v226, v248
  s_waitcnt lgkmcnt(0)
  v_mfma_f32_32x32x16_bf16 v[128:143], v[176:179], v[48:51], v[128:143]
  ds_read_b64_tr_b16 v[192:193], v212 offset:61440
  ds_read_b64_tr_b16 v[194:195], v212 offset:61952
  ds_read_b64_tr_b16 v[196:197], v213 offset:61440
  ds_read_b64_tr_b16 v[198:199], v213 offset:61952
  v_fmac_f32 v245, v226, v249
  v_fma_f32 v244, -v227, v249, v244
  v_fmac_f32 v245, v227, v248
  ds_write_b64 v221, v[244:245]
  v_cndmask_b32 v246, 0, v246, s[76:77]
  v_mfma_f32_32x32x16_bf16 v[144:159], v[180:183], v[48:51], v[144:159]
  ds_read_b64_tr_b16 v[200:201], v212 offset:63488
  ds_read_b64_tr_b16 v[202:203], v212 offset:64000
  ds_read_b64_tr_b16 v[204:205], v213 offset:63488
  ds_read_b64_tr_b16 v[206:207], v213 offset:64000
  v_cndmask_b32 v247, 0, v247, s[76:77]
  v_cndmask_b32 v208, v246, v248, s[78:79]
  v_cndmask_b32 v209, v247, v249, s[78:79]
  v_fmac_f32 v246, v224, v248
  v_fmac_f32 v247, v224, v249
  v_mfma_f32_32x32x16_bf16 v[128:143], v[184:187], v[52:55], v[128:143]
  v_fma_f32 v246, -v225, v249, v246
  v_fmac_f32 v247, v225, v248
  v_cndmask_b32 v208, v208, v246, s[80:81]
  v_cndmask_b32 v209, v209, v247, s[80:81]
  v_mfma_f32_32x32x16_bf16 v[144:159], v[188:191], v[52:55], v[144:159]
  s_waitcnt lgkmcnt(0)
  v_mfma_f32_32x32x16_bf16 v[128:143], v[192:195], v[56:59], v[128:143]
  v_and_b32 v210, 15, v220
  v_lshlrev_b32 v210, 2, v210
  buffer_load_dword v210, v210, s[28:31], s45 offen sc1
  s_waitcnt vmcnt(9) lgkmcnt(0)
  s_barrier
  s_add_u32 m0, s71, 49152
  s_lshl4_add_u32 s74, s40, s96
  v_mfma_f32_32x32x16_bf16 v[144:159], v[196:199], v[56:59], v[144:159]
  ds_read_b64_tr_b16 v[176:177], v212 offset:0
  ds_read_b64_tr_b16 v[178:179], v212 offset:512
  ds_read_b64_tr_b16 v[180:181], v213 offset:0
  ds_read_b64_tr_b16 v[182:183], v213 offset:512
  buffer_load_dwordx4 v218, s[8:11], s74 offen lds
  s_lshl4_add_u32 s74, s40, s96
  v_mfma_f32_32x32x16_bf16 v[128:143], v[200:203], v[60:63], v[128:143]
  ds_read_b64_tr_b16 v[184:185], v212 offset:2048
  ds_read_b64_tr_b16 v[186:187], v212 offset:2560
  ds_read_b64_tr_b16 v[188:189], v213 offset:2048
  ds_read_b64_tr_b16 v[190:191], v213 offset:2560
  buffer_load_dwordx4 v253, s[8:11], s74 offen offset:1024 lds
  s_add_u32 m0, s71, 114688
  s_lshl4_add_u32 s74, s41, s96
  v_mfma_f32_32x32x16_bf16 v[144:159], v[204:207], v[60:63], v[144:159]
  buffer_load_dwordx4 v218, s[8:11], s74 offen lds
  s_waitcnt lgkmcnt(0)
  s_lshl4_add_u32 s74, s41, s96
  v_mfma_f32_32x32x16_bf16 v[128:143], v[176:179], v[64:67], v[128:143]
  ds_read_b64_tr_b16 v[192:193], v212 offset:4096
  ds_read_b64_tr_b16 v[194:195], v212 offset:4608
  ds_read_b64_tr_b16 v[196:197], v213 offset:4096
  ds_read_b64_tr_b16 v[198:199], v213 offset:4608
  buffer_load_dwordx4 v253, s[8:11], s74 offen offset:1024 lds
  s_lshl_b32 s3, s7, 7
  v_subrev_u32 v252, s3, v221
  ds_read_b64 v[242:243], v252 offset:0
  ds_read_b64 v[244:245], v252 offset:128
  ds_read_b64 v[246:247], v252 offset:256
  ds_read_b64 v[248:249], v252 offset:384
  v_mfma_f32_32x32x16_bf16 v[144:159], v[180:183], v[64:67], v[144:159]
  ds_read_b64_tr_b16 v[200:201], v212 offset:6144
  ds_read_b64_tr_b16 v[202:203], v212 offset:6656
  ds_read_b64_tr_b16 v[204:205], v213 offset:6144
  ds_read_b64_tr_b16 v[206:207], v213 offset:6656
  s_waitcnt lgkmcnt(4)
  v_fmac_f32 v244, v228, v242
  v_fmac_f32 v245, v228, v243
  v_fma_f32 v244, -v229, v243, v244
  v_fmac_f32 v245, v229, v242
  v_mfma_f32_32x32x16_bf16 v[128:143], v[184:187], v[68:71], v[128:143]
  v_fmac_f32 v246, v228, v244
  v_fmac_f32 v247, v228, v245
  v_fma_f32 v246, -v229, v245, v246
  v_fmac_f32 v247, v229, v244
  v_fmac_f32 v248, v228, v246
  v_mfma_f32_32x32x16_bf16 v[144:159], v[188:191], v[68:71], v[144:159]
  v_fmac_f32 v249, v228, v247
  v_fma_f32 v248, -v229, v247, v248
  v_fmac_f32 v249, v229, v246
  v_cmp_eq_u32 vcc, -1, v248
  v_mov_b32 v252, 0x7fc00000
  s_nop 0
  v_cndmask_b32 v248, v248, v252, vcc
  v_cmp_eq_u32 vcc, -1, v249
  v_mov_b32 v252, 0x7fc00000
  s_nop 0
  v_cndmask_b32 v249, v249, v252, vcc
  s_waitcnt lgkmcnt(0)
  v_mfma_f32_32x32x16_bf16 v[128:143], v[192:195], v[72:75], v[128:143]
  ds_read_b64_tr_b16 v[176:177], v212 offset:8192
  ds_read_b64_tr_b16 v[178:179], v212 offset:8704
  ds_read_b64_tr_b16 v[180:181], v213 offset:8192
  ds_read_b64_tr_b16 v[182:183], v213 offset:8704
  s_waitcnt vmcnt(4)
  s_mov_b32 s94, 0
L16:
  v_cmp_gt_i32 vcc, 1, v210
  s_add_u32 s94, s94, 1
  s_nop 2
  s_and_b32 s3, vcc_lo, 0x3fff
  s_cbranch_scc0 L15
  s_cmp_ge_u32 s94, 0x8000
  s_cbranch_scc1 L15
  s_sleep 2
  v_and_b32 v210, 15, v220
  v_lshlrev_b32 v210, 2, v210
  buffer_load_dword v210, v210, s[28:31], s45 offen sc1
  s_waitcnt vmcnt(0)
  s_branch L16
L15:
  v_and_b32 v252, 15, v220
  v_lshlrev_b32 v252, 3, v252
  s_lshl_b32 s3, s5, 8
  s_lshl_b32 s74, s70, 7
  s_add_u32 s3, s3, s74
  s_cmp_eq_u32 s7, 0
  s_cselect_b32 s3, s3, 0x10000
  v_add_u32 v252, s3, v252
  s_mov_b64 exec, 0xffff
  buffer_store_dwordx2 v[248:249], v252, s[88:91], 0 offen sc1
  s_mov_b64 exec, -1
  v_cndmask_b32 v250, 0, v242, s[82:83]
  s_add_u32 s74, s100, s38
  v_mfma_f32_32x32x16_bf16 v[144:159], v[196:199], v[72:75], v[144:159]
  ds_read_b64_tr_b16 v[184:185], v212 offset:10240
  ds_read_b64_tr_b16 v[186:187], v212 offset:10752
  ds_read_b64_tr_b16 v[188:189], v213 offset:10240
  ds_read_b64_tr_b16 v[190:191], v213 offset:10752
  buffer_load_dwordx4 v[0:3], v219, s[28:31], s74 offen sc1
  v_cndmask_b32 v250, v250, v244, s[84:85]
  v_cndmask_b32 v250, v250, v246, s[86:87]
  v_cndmask_b32 v251, 0, v243, s[82:83]
  v_cndmask_b32 v251, v251, v245, s[84:85]
  v_cndmask_b32 v251, v251, v247, s[86:87]
  s_add_u32 s74, s100, s38
  v_mfma_f32_32x32x16_bf16 v[128:143], v[200:203], v[76:79], v[128:143]
  buffer_load_dwordx4 v[4:7], v214, s[28:31], s74 offen sc1
  v_fmac_f32 v208, v236, v250
  v_fmac_f32 v209, v236, v251
  v_fma_f32 v208, -v237, v251, v208
  v_fmac_f32 v209, v237, v250
  s_add_u32 s74, s100, s39
  v_mfma_f32_32x32x16_bf16 v[144:159], v[204:207], v[76:79], v[144:159]
  buffer_load_dwordx4 v[8:11], v219, s[28:31], s74 offen sc1
  s_waitcnt lgkmcnt(0)
  s_add_u32 s74, s100, s39
  v_mfma_f32_32x32x16_bf16 v[128:143], v[176:179], v[80:83], v[128:143]
  ds_read_b64_tr_b16 v[192:193], v212 offset:12288
  ds_read_b64_tr_b16 v[194:195], v212 offset:12800
  ds_read_b64_tr_b16 v[196:197], v213 offset:12288
  ds_read_b64_tr_b16 v[198:199], v213 offset:12800
  buffer_load_dwordx4 v[12:15], v214, s[28:31], s74 offen sc1
  s_add_u32 s74, s100, s40
  v_mfma_f32_32x32x16_bf16 v[144:159], v[180:183], v[80:83], v[144:159]
  ds_read_b64_tr_b16 v[200:201], v212 offset:14336
  ds_read_b64_tr_b16 v[202:203], v212 offset:14848
  ds_read_b64_tr_b16 v[204:205], v213 offset:14336
  ds_read_b64_tr_b16 v[206:207], v213 offset:14848
  buffer_load_dwordx4 v[16:19], v219, s[28:31], s74 offen sc1
  s_add_u32 s74, s100, s40
  v_mfma_f32_32x32x16_bf16 v[128:143], v[184:187], v[84:87], v[128:143]
  buffer_load_dwordx4 v[20:23], v214, s[28:31], s74 offen sc1
  v_mfma_f32_32x32x16_bf16 v[144:159], v[188:191], v[84:87], v[144:159]
  s_waitcnt lgkmcnt(0)
  v_mfma_f32_32x32x16_bf16 v[128:143], v[192:195], v[88:91], v[128:143]
  s_waitcnt lgkmcnt(0)
  s_barrier
  s_add_u32 m0, s71, 147456
  s_lshl4_add_u32 s74, s42, s96
  v_mfma_f32_32x32x16_bf16 v[144:159], v[196:199], v[88:91], v[144:159]
  ds_read_b64_tr_b16 v[176:177], v212 offset:16384
  ds_read_b64_tr_b16 v[178:179], v212 offset:16896
  ds_read_b64_tr_b16 v[180:181], v213 offset:16384
  ds_read_b64_tr_b16 v[182:183], v213 offset:16896
  buffer_load_dwordx4 v218, s[8:11], s74 offen lds
  s_lshl4_add_u32 s74, s42, s96
  v_mfma_f32_32x32x16_bf16 v[128:143], v[200:203], v[92:95], v[128:143]
  ds_read_b64_tr_b16 v[184:185], v212 offset:18432
  ds_read_b64_tr_b16 v[186:187], v212 offset:18944
  ds_read_b64_tr_b16 v[188:189], v213 offset:18432
  ds_read_b64_tr_b16 v[190:191], v213 offset:18944
  buffer_load_dwordx4 v253, s[8:11], s74 offen offset:1024 lds
  s_add_u32 m0, s71, 0
  s_lshl4_add_u32 s74, s43, s96
  v_mfma_f32_32x32x16_bf16 v[144:159], v[204:207], v[92:95], v[144:159]
  buffer_load_dwordx4 v218, s[8:11], s74 offen lds
  s_waitcnt lgkmcnt(0)
  s_lshl4_add_u32 s74, s43, s96
  v_mfma_f32_32x32x16_bf16 v[128:143], v[176:179], v[96:99], v[128:143]
  ds_read_b64_tr_b16 v[192:193], v212 offset:20480
  ds_read_b64_tr_b16 v[194:195], v212 offset:20992
  ds_read_b64_tr_b16 v[196:197], v213 offset:20480
  ds_read_b64_tr_b16 v[198:199], v213 offset:20992
  buffer_load_dwordx4 v253, s[8:11], s74 offen offset:1024 lds
  v_lshrrev_b32 v211, 4, v220
  v_lshlrev_b32 v211, 10, v211
  v_and_b32 v242, 15, v220
  v_lshl_add_u32 v211, v242, 3, v211
  s_sub_u32 s3, s5, 16
  s_lshl_b32 s3, s3, 8
  s_lshl_b32 s74, s70, 7
  s_add_u32 s3, s3, s74
  v_add_u32 v211, s3, v211
  s_add_u32 m0, s71, 65536
  s_lshl4_add_u32 s74, s44, s96
  v_mfma_f32_32x32x16_bf16 v[144:159], v[180:183], v[96:99], v[144:159]
  ds_read_b64_tr_b16 v[200:201], v212 offset:22528
  ds_read_b64_tr_b16 v[202:203], v212 offset:23040
  ds_read_b64_tr_b16 v[204:205], v213 offset:22528
  ds_read_b64_tr_b16 v[206:207], v213 offset:23040
  buffer_load_dwordx4 v218, s[8:11], s74 offen lds
  s_lshl4_add_u32 s74, s44, s96
  v_mfma_f32_32x32x16_bf16 v[128:143], v[184:187], v[100:103], v[128:143]
  buffer_load_dwordx4 v253, s[8:11], s74 offen offset:1024 lds
  v_mfma_f32_32x32x16_bf16 v[144:159], v[188:191], v[100:103], v[144:159]
  s_waitcnt lgkmcnt(0)
  v_mfma_f32_32x32x16_bf16 v[128:143], v[192:195], v[104:107], v[128:143]
  ds_read_b64_tr_b16 v[176:177], v212 offset:24576
  ds_read_b64_tr_b16 v[178:179], v212 offset:25088
  ds_read_b64_tr_b16 v[180:181], v213 offset:24576
  ds_read_b64_tr_b16 v[182:183], v213 offset:25088
  v_mfma_f32_32x32x16_bf16 v[144:159], v[196:199], v[104:107], v[144:159]
  ds_read_b64_tr_b16 v[184:185], v212 offset:26624
  ds_read_b64_tr_b16 v[186:187], v212 offset:27136
  ds_read_b64_tr_b16 v[188:189], v213 offset:26624
  ds_read_b64_tr_b16 v[190:191], v213 offset:27136
  v_mfma_f32_32x32x16_bf16 v[128:143], v[200:203], v[108:111], v[128:143]
  v_mfma_f32_32x32x16_bf16 v[144:159], v[204:207], v[108:111], v[144:159]
  s_waitcnt lgkmcnt(0)
  v_mfma_f32_32x32x16_bf16 v[128:143], v[176:179], v[112:115], v[128:143]
  ds_read_b64_tr_b16 v[192:193], v212 offset:28672
  ds_read_b64_tr_b16 v[194:195], v212 offset:29184
  ds_read_b64_tr_b16 v[196:197], v213 offset:28672
  ds_read_b64_tr_b16 v[198:199], v213 offset:29184
  v_mfma_f32_32x32x16_bf16 v[144:159], v[180:183], v[112:115], v[144:159]
  ds_read_b64_tr_b16 v[200:201], v212 offset:30720
  ds_read_b64_tr_b16 v[202:203], v212 offset:31232
  ds_read_b64_tr_b16 v[204:205], v213 offset:30720
  ds_read_b64_tr_b16 v[206:207], v213 offset:31232
  v_mfma_f32_32x32x16_bf16 v[128:143], v[184:187], v[116:119], v[128:143]
  v_mfma_f32_32x32x16_bf16 v[144:159], v[188:191], v[116:119], v[144:159]
  s_waitcnt lgkmcnt(0)
  v_mfma_f32_32x32x16_bf16 v[128:143], v[192:195], v[120:123], v[128:143]
  v_xor_b32 v216, 64, v215
  v_add_u32 v212, 0x10000, v215
  v_add_u32 v213, 0x10000, v216
  v_add_u32 v242, 0, v211
  v_add_u32 v244, 256, v211
  v_add_u32 v246, 512, v211
  v_add_u32 v248, 768, v211
  buffer_load_dwordx2 v[242:243], v242, s[88:91], 0 offen sc1
  buffer_load_dwordx2 v[244:245], v244, s[88:91], 0 offen sc1
  buffer_load_dwordx2 v[246:247], v246, s[88:91], 0 offen sc1
  buffer_load_dwordx2 v[248:249], v248, s[88:91], 0 offen sc1
  v_mfma_f32_32x32x16_bf16 v[144:159], v[196:199], v[120:123], v[144:159]
  v_add_u32 v217, 0x20000, v215
  v_add_u32 v221, 0x20000, v216
  ds_read_b64_tr_b16 v[176:177], v215 offset:32768
  ds_read_b64_tr_b16 v[178:179], v215 offset:33792
  v_mfma_f32_32x32x16_bf16 v[128:143], v[200:203], v[124:127], v[128:143]
  ds_read_b64_tr_b16 v[180:181], v216 offset:32768
  ds_read_b64_tr_b16 v[182:183], v216 offset:33792
  v_mfma_f32_32x32x16_bf16 v[144:159], v[204:207], v[124:127], v[144:159]
  s_waitcnt lgkmcnt(0)
  s_nop 7
  s_nop 1
  s_mov_b32 s84, 0xbfb8aa3b
  s_mov_b32 s85, 0xbfb8aa3b
  s_mov_b32 s86, 1.0
  s_mov_b32 s87, 1.0
  v_pk_mul_f32 v[136:137], v[128:129], v[136:137]
  v_pk_mul_f32 v[128:129], v[128:129], s[84:85]
  v_pk_mul_f32 v[138:139], v[130:131], v[138:139]
  v_pk_mul_f32 v[130:131], v[130:131], s[84:85]
  v_pk_mul_f32 v[140:141], v[132:133], v[140:141]
  v_pk_mul_f32 v[132:133], v[132:133], s[84:85]
  v_pk_mul_f32 v[142:143], v[134:135], v[142:143]
  v_pk_mul_f32 v[134:135], v[134:135], s[84:85]
  v_exp_f32 v128, v128
  v_exp_f32 v129, v129
  v_exp_f32 v130, v130
  v_exp_f32 v131, v131
  v_exp_f32 v132, v132
  v_exp_f32 v133, v133
  v_exp_f32 v134, v134
  v_exp_f32 v135, v135
  v_pk_add_f32 v[128:129], v[128:129], s[86:87]
  v_pk_add_f32 v[130:131], v[130:131], s[86:87]
  v_pk_add_f32 v[132:133], v[132:133], s[86:87]
  v_pk_add_f32 v[134:135], v[134:135], s[86:87]
  v_rcp_f32 v128, v128
  v_rcp_f32 v129, v129
  v_rcp_f32 v130, v130
  v_rcp_f32 v131, v131
  v_rcp_f32 v132, v132
  v_rcp_f32 v133, v133
  v_rcp_f32 v134, v134
  v_rcp_f32 v135, v135
  v_pk_mul_f32 v[136:137], v[128:129], v[136:137]
  v_pk_mul_f32 v[138:139], v[130:131], v[138:139]
  v_pk_mul_f32 v[140:141], v[132:133], v[140:141]
  v_pk_mul_f32 v[142:143], v[134:135], v[142:143]
  v_cvt_pk_bf16_f32 v128, v136, v137
  v_cvt_pk_bf16_f32 v129, v138, v139
  v_cvt_pk_bf16_f32 v130, v140, v141
  v_cvt_pk_bf16_f32 v131, v142, v143
  s_add_u32 s74, s75, 4096
  buffer_store_dwordx4 v[128:131], v219, s[32:35], s74 offen sc1
  v_pk_mul_f32 v[152:153], v[144:145], v[152:153]
  v_pk_mul_f32 v[144:145], v[144:145], s[84:85]
  v_pk_mul_f32 v[154:155], v[146:147], v[154:155]
  v_pk_mul_f32 v[146:147], v[146:147], s[84:85]
  v_pk_mul_f32 v[156:157], v[148:149], v[156:157]
  v_pk_mul_f32 v[148:149], v[148:149], s[84:85]
  v_pk_mul_f32 v[158:159], v[150:151], v[158:159]
  v_pk_mul_f32 v[150:151], v[150:151], s[84:85]
  v_exp_f32 v144, v144
  v_exp_f32 v145, v145
  v_exp_f32 v146, v146
  v_exp_f32 v147, v147
  v_exp_f32 v148, v148
  v_exp_f32 v149, v149
  v_exp_f32 v150, v150
  v_exp_f32 v151, v151
  v_pk_add_f32 v[144:145], v[144:145], s[86:87]
  v_pk_add_f32 v[146:147], v[146:147], s[86:87]
  v_pk_add_f32 v[148:149], v[148:149], s[86:87]
  v_pk_add_f32 v[150:151], v[150:151], s[86:87]
  v_rcp_f32 v144, v144
  v_rcp_f32 v145, v145
  v_rcp_f32 v146, v146
  v_rcp_f32 v147, v147
  v_rcp_f32 v148, v148
  v_rcp_f32 v149, v149
  v_rcp_f32 v150, v150
  v_rcp_f32 v151, v151
  v_pk_mul_f32 v[152:153], v[144:145], v[152:153]
  v_pk_mul_f32 v[154:155], v[146:147], v[154:155]
  v_pk_mul_f32 v[156:157], v[148:149], v[156:157]
  v_pk_mul_f32 v[158:159], v[150:151], v[158:159]
  v_cvt_pk_bf16_f32 v144, v152, v153
  v_cvt_pk_bf16_f32 v145, v154, v155
  v_cvt_pk_bf16_f32 v146, v156, v157
  v_cvt_pk_bf16_f32 v147, v158, v159
  s_add_u32 s74, s75, 5120
  buffer_store_dwordx4 v[144:147], v219, s[32:35], s74 offen sc1
  s_waitcnt vmcnt(2)
  s_mov_b32 s94, 0
L18:
  v_max3_u32 v250, v242, v243, v244
  v_max3_u32 v250, v250, v245, v246
  v_max3_u32 v250, v250, v247, v248
  v_max_u32 v250, v250, v249
  v_cmp_eq_u32 vcc, -1, v250
  s_add_u32 s94, s94, 1
  s_nop 3
  s_cbranch_vccz L17
  s_cmp_ge_u32 s94, 0x8000
  s_cbranch_scc1 L17
  s_sleep 1
  v_add_u32 v242, 0, v211
  v_add_u32 v244, 256, v211
  v_add_u32 v246, 512, v211
  v_add_u32 v248, 768, v211
  buffer_load_dwordx2 v[242:243], v242, s[88:91], 0 offen sc1
  buffer_load_dwordx2 v[244:245], v244, s[88:91], 0 offen sc1
  buffer_load_dwordx2 v[246:247], v246, s[88:91], 0 offen sc1
  buffer_load_dwordx2 v[248:249], v248, s[88:91], 0 offen sc1
  s_waitcnt vmcnt(0)
  s_branch L18
L17:
  v_fmac_f32 v244, v230, v242
  v_fmac_f32 v245, v230, v243
  v_fma_f32 v244, -v231, v243, v244
  v_fmac_f32 v245, v231, v242
  v_fmac_f32 v246, v230, v244
  v_fmac_f32 v247, v230, v245
  v_fma_f32 v246, -v231, v245, v246
  v_fmac_f32 v247, v231, v244
  v_fmac_f32 v248, v230, v246
  v_fmac_f32 v249, v230, v247
  v_fma_f32 v248, -v231, v247, v248
  v_fmac_f32 v249, v231, v246
  v_mov_b32 v242, v248
  v_mov_b32 v243, v249
  s_nop 1
  v_permlane16_swap_b32 v242, v248
  v_permlane16_swap_b32 v243, v249
  s_nop 0
  v_fmac_f32 v248, v232, v242
  v_fmac_f32 v249, v232, v243
  v_fma_f32 v248, -v233, v243, v248
  v_fmac_f32 v249, v233, v242
  v_mov_b32 v244, v248
  v_mov_b32 v245, v249
  s_nop 1
  v_permlane32_swap_b32 v244, v248
  v_permlane32_swap_b32 v245, v249
  s_nop 0
  v_fmac_f32 v248, v234, v244
  v_fmac_f32 v249, v234, v245
  v_fma_f32 v248, -v235, v245, v248
  v_fmac_f32 v249, v235, v244
  v_fmac_f32 v208, v238, v248
  v_fmac_f32 v209, v238, v249
  v_fma_f32 v208, -v239, v249, v208
  v_fmac_f32 v209, v239, v248
  v_fmac_f32 v160, v222, v208
  v_fmac_f32 v168, v222, v209
  v_fma_f32 v160, -v223, v209, v160
  v_fmac_f32 v168, v223, v208
  v_fmac_f32 v161, v222, v160
  v_fmac_f32 v169, v222, v168
  v_fma_f32 v161, -v223, v168, v161
  v_fmac_f32 v169, v223, v160
  v_fmac_f32 v162, v222, v161
  v_fmac_f32 v170, v222, v169
  v_fma_f32 v162, -v223, v169, v162
  v_fmac_f32 v170, v223, v161
  v_fmac_f32 v163, v222, v162
  v_fmac_f32 v171, v222, v170
  v_fma_f32 v163, -v223, v170, v163
  v_fmac_f32 v171, v223, v162
  v_fmac_f32 v164, v222, v163
  v_fmac_f32 v172, v222, v171
  v_fma_f32 v164, -v223, v171, v164
  v_fmac_f32 v172, v223, v163
  v_fmac_f32 v165, v222, v164
  v_fmac_f32 v173, v222, v172
  v_fma_f32 v165, -v223, v172, v165
  v_fmac_f32 v173, v223, v164
  v_fmac_f32 v166, v222, v165
  v_fmac_f32 v174, v222, v173
  v_fma_f32 v166, -v223, v173, v166
  v_fmac_f32 v174, v223, v165
  v_fmac_f32 v167, v222, v166
  v_fmac_f32 v175, v222, v174
  v_fma_f32 v167, -v223, v174, v167
  v_fmac_f32 v175, v223, v166
  v_and_b32 v250, 15, v220
  v_lshlrev_b32 v250, 6, v250
  v_and_or_b32 v250, v220, 48, v250
  s_add_u32 s3, s71, 131072
  v_add_u32 v250, s3, v250
  v_lshrrev_b32 v251, 5, v220
  v_bfe_u32 v252, v220, 2, 2
  v_lshl_add_u32 v251, v251, 3, v252
  v_lshlrev_b32 v251, 6, v251
  v_and_b32 v252, 1, v220
  v_lshl_add_u32 v251, v252, 5, v251
  v_and_or_b32 v251, v220, 16, v251
  v_and_b32 v252, 2, v220
  v_lshl_add_u32 v251, v252, 2, v251
  s_add_u32 s3, s71, 131072
  v_add_u32 v251, s3, v251
  v_cvt_pk_bf16_f32 v242, v160, v161
  v_cvt_pk_bf16_f32 v243, v162, v163
  v_cvt_pk_bf16_f32 v244, v164, v165
  v_cvt_pk_bf16_f32 v245, v166, v167
  v_cvt_pk_bf16_f32 v246, -v168, -v169
  v_cvt_pk_bf16_f32 v247, -v170, -v171
  v_cvt_pk_bf16_f32 v248, -v172, -v173
  v_cvt_pk_bf16_f32 v249, -v174, -v175
  ds_write_b128 v250, v[242:245] offset:0
  ds_write_b128 v250, v[246:249] offset:1024
  s_waitcnt lgkmcnt(0)
  ds_read_b64_tr_b16 v[160:161], v251 offset:0
  ds_read_b64_tr_b16 v[162:163], v251 offset:256
  ds_read_b64_tr_b16 v[164:165], v251 offset:1024
  ds_read_b64_tr_b16 v[166:167], v251 offset:1280
  s_waitcnt lgkmcnt(0)
  s_add_u32 s74, s95, 0
  buffer_store_dwordx4 v[160:163], v219, s[28:31], s74 offen sc1
  s_add_u32 s74, s95, 32768
  buffer_store_dwordx4 v[164:167], v219, s[28:31], s74 offen sc1
  s_barrier
  s_add_u32 s74, s100, s41
  buffer_load_dwordx4 v[24:27], v219, s[28:31], s74 offen sc1
  s_add_u32 s74, s100, s41
  v_mfma_f32_32x32x16_bf16 v[64:79], v[176:179], v[0:3], 0
  ds_read_b64_tr_b16 v[184:185], v212 offset:32768
  ds_read_b64_tr_b16 v[186:187], v212 offset:33792
  ds_read_b64_tr_b16 v[188:189], v213 offset:32768
  buffer_load_dwordx4 v[28:31], v214, s[28:31], s74 offen sc1
  s_add_u32 s74, s100, s42
  v_mfma_f32_32x32x16_bf16 v[80:95], v[176:179], v[4:7], 0
  ds_read_b64_tr_b16 v[190:191], v213 offset:33792
  buffer_load_dwordx4 v[32:35], v219, s[28:31], s74 offen sc1
  s_add_u32 s74, s100, s42
  v_mfma_f32_32x32x16_bf16 v[96:111], v[180:183], v[0:3], 0
  buffer_load_dwordx4 v[36:39], v214, s[28:31], s74 offen sc1
  s_add_u32 s74, s100, s43
  v_mfma_f32_32x32x16_bf16 v[112:127], v[180:183], v[4:7], 0
  buffer_load_dwordx4 v[40:43], v219, s[28:31], s74 offen sc1
  s_waitcnt lgkmcnt(0)
  s_waitcnt vmcnt(5)
  s_barrier
  s_cmp_lg_u32 s4, 0
  s_cbranch_scc1 L19
  s_lshl_b32 s3, s5, 11
  s_add_u32 s3, s3, s6
  s_lshl_b32 s3, s3, 2
  s_add_u32 s3, s3, 12718080
  v_mov_b32 v254, 3
  s_mov_b64 exec, 1
  buffer_store_dword v254, off, s[28:31], s3 sc1
  s_mov_b64 exec, -1
L19:
  s_add_u32 s74, s100, s43
  v_mfma_f32_32x32x16_bf16 v[64:79], v[184:187], v[8:11], v[64:79]
  ds_read_b64_tr_b16 v[176:177], v215 offset:49152
  ds_read_b64_tr_b16 v[178:179], v215 offset:50176
  ds_read_b64_tr_b16 v[180:181], v216 offset:49152
  buffer_load_dwordx4 v[44:47], v214, s[28:31], s74 offen sc1
  s_add_u32 s74, s100, s44
  v_mfma_f32_32x32x16_bf16 v[80:95], v[184:187], v[12:15], v[80:95]
  ds_read_b64_tr_b16 v[182:183], v216 offset:50176
  buffer_load_dwordx4 v[48:51], v219, s[28:31], s74 offen sc1
  s_add_u32 s74, s100, s44
  v_mfma_f32_32x32x16_bf16 v[96:111], v[188:191], v[8:11], v[96:111]
  buffer_load_dwordx4 v[52:55], v214, s[28:31], s74 offen sc1
  s_add_u32 m0, s71, 16384
  s_lshl4_add_u32 s74, s38, s97
  v_mfma_f32_32x32x16_bf16 v[112:127], v[188:191], v[12:15], v[112:127]
  buffer_load_dwordx4 v218, s[8:11], s74 offen lds
  s_waitcnt lgkmcnt(0)
  s_lshl4_add_u32 s74, s38, s97
  v_mfma_f32_32x32x16_bf16 v[64:79], v[176:179], v[16:19], v[64:79]
  ds_read_b64_tr_b16 v[184:185], v212 offset:49152
  ds_read_b64_tr_b16 v[186:187], v212 offset:50176
  ds_read_b64_tr_b16 v[188:189], v213 offset:49152
  buffer_load_dwordx4 v253, s[8:11], s74 offen offset:1024 lds
  s_add_u32 m0, s71, 81920
  s_lshl4_add_u32 s74, s39, s97
  v_mfma_f32_32x32x16_bf16 v[80:95], v[176:179], v[20:23], v[80:95]
  ds_read_b64_tr_b16 v[190:191], v213 offset:50176
  buffer_load_dwordx4 v218, s[8:11], s74 offen lds
  s_lshl4_add_u32 s74, s39, s97
  v_mfma_f32_32x32x16_bf16 v[96:111], v[180:183], v[16:19], v[96:111]
  buffer_load_dwordx4 v253, s[8:11], s74 offen offset:1024 lds
  s_add_u32 m0, s71, 131072
  s_lshl4_add_u32 s74, s40, s97
  v_mfma_f32_32x32x16_bf16 v[112:127], v[180:183], v[20:23], v[112:127]
  buffer_load_dwordx4 v218, s[8:11], s74 offen lds
  s_waitcnt lgkmcnt(0)
  s_waitcnt vmcnt(11)
  s_lshl4_add_u32 s74, s40, s97
  v_mfma_f32_32x32x16_bf16 v[64:79], v[184:187], v[24:27], v[64:79]
  ds_read_b64_tr_b16 v[176:177], v217 offset:16384
  ds_read_b64_tr_b16 v[178:179], v217 offset:17408
  ds_read_b64_tr_b16 v[180:181], v221 offset:16384
  buffer_load_dwordx4 v253, s[8:11], s74 offen offset:1024 lds
  s_add_u32 m0, s71, 32768
  s_lshl4_add_u32 s74, s41, s97
  v_mfma_f32_32x32x16_bf16 v[80:95], v[184:187], v[28:31], v[80:95]
  ds_read_b64_tr_b16 v[182:183], v221 offset:17408
  buffer_load_dwordx4 v218, s[8:11], s74 offen lds
  s_lshl4_add_u32 s74, s41, s97
  v_mfma_f32_32x32x16_bf16 v[96:111], v[188:191], v[24:27], v[96:111]
  buffer_load_dwordx4 v253, s[8:11], s74 offen offset:1024 lds
  s_add_u32 m0, s71, 98304
  s_lshl4_add_u32 s74, s42, s97
  v_mfma_f32_32x32x16_bf16 v[112:127], v[188:191], v[28:31], v[112:127]
  buffer_load_dwordx4 v218, s[8:11], s74 offen lds
  s_waitcnt lgkmcnt(0)
  s_waitcnt vmcnt(13)
  s_lshl4_add_u32 s74, s42, s97
  v_mfma_f32_32x32x16_bf16 v[64:79], v[176:179], v[32:35], v[64:79]
  ds_read_b64_tr_b16 v[184:185], v215 offset:0
  ds_read_b64_tr_b16 v[186:187], v215 offset:1024
  ds_read_b64_tr_b16 v[188:189], v216 offset:0
  buffer_load_dwordx4 v253, s[8:11], s74 offen offset:1024 lds
  s_add_u32 m0, s71, 49152
  s_lshl4_add_u32 s74, s43, s97
  v_mfma_f32_32x32x16_bf16 v[80:95], v[176:179], v[36:39], v[80:95]
  ds_read_b64_tr_b16 v[190:191], v216 offset:1024
  buffer_load_dwordx4 v218, s[8:11], s74 offen lds
  s_lshl4_add_u32 s74, s43, s97
  v_mfma_f32_32x32x16_bf16 v[96:111], v[180:183], v[32:35], v[96:111]
  buffer_load_dwordx4 v253, s[8:11], s74 offen offset:1024 lds
  s_add_u32 m0, s71, 114688
  s_lshl4_add_u32 s74, s44, s97
  v_mfma_f32_32x32x16_bf16 v[112:127], v[180:183], v[36:39], v[112:127]
  buffer_load_dwordx4 v218, s[8:11], s74 offen lds
  s_waitcnt lgkmcnt(0)
  s_waitcnt vmcnt(15)
  s_lshl4_add_u32 s74, s44, s97
  v_mfma_f32_32x32x16_bf16 v[64:79], v[184:187], v[40:43], v[64:79]
  ds_read_b64_tr_b16 v[176:177], v212 offset:0
  ds_read_b64_tr_b16 v[178:179], v212 offset:1024
  ds_read_b64_tr_b16 v[180:181], v213 offset:0
  buffer_load_dwordx4 v253, s[8:11], s74 offen offset:1024 lds
  v_mfma_f32_32x32x16_bf16 v[80:95], v[184:187], v[44:47], v[80:95]
  ds_read_b64_tr_b16 v[182:183], v213 offset:1024
  v_mfma_f32_32x32x16_bf16 v[96:111], v[188:191], v[40:43], v[96:111]
  v_mfma_f32_32x32x16_bf16 v[112:127], v[188:191], v[44:47], v[112:127]
  s_waitcnt lgkmcnt(0)
  s_waitcnt vmcnt(14)
  v_mfma_f32_32x32x16_bf16 v[64:79], v[176:179], v[48:51], v[64:79]
  s_waitcnt vmcnt(12)
  v_mfma_f32_32x32x16_bf16 v[80:95], v[176:179], v[52:55], v[80:95]
  v_mfma_f32_32x32x16_bf16 v[96:111], v[180:183], v[48:51], v[96:111]
  v_mfma_f32_32x32x16_bf16 v[112:127], v[180:183], v[52:55], v[112:127]
Lp1end:
  s_and_b32 s3, s4, 1
  s_cmp_eq_u32 s3, 1
  s_cselect_b32 s20, s48, s46
  s_cselect_b32 s21, s49, s47
  s_mov_b32 s22, 0x80000
  s_mov_b32 s23, 0x20000
  s_lshl_b32 s3, s3, 5
  s_add_u32 s3, s3, 112
  s_lshr_b32 s82, s4, 1
  s_lshl_b32 s74, s82, 2
  s_add_u32 s3, s3, s74
  s_lshl_b32 s3, s3, 10
  s_add_u32 s80, s73, s3
  s_lshl_b32 s82, s82, 7
  s_lshr_b32 s3, s99, 2
  s_xor_b32 s3, s3, s98
  s_and_b32 s3, s3, 1
  s_lshl_b32 s74, s3, 14
  s_xor_b32 s81, s74, 0x4000
  s_add_u32 s81, s81, s80
  s_add_u32 s80, s80, s74
  s_lshl_b32 s74, s3, 9
  s_xor_b32 s83, s74, 0x200
  s_add_u32 s83, s83, s82
  s_add_u32 s82, s82, s74
  v_lshrrev_b32 v194, 3, v220
  v_lshrrev_b32 v254, 4, v220
  v_xor_b32 v254, v254, v220
  v_and_b32 v254, 7, v254
  s_lshl_b32 s3, s99, 16
  v_lshl_add_u32 v254, v254, 4, s3
  v_lshl_add_u32 v193, v194, 10, v254
  v_xor_b32 v194, 64, v193
  s_add_u32 m0, s71, 0
  s_add_u32 s74, s82, 0
  buffer_load_dwordx4 v193, s[20:23], s74 offen lds
  s_add_u32 s74, s82, 7168
  buffer_load_dwordx4 v194, s[20:23], s74 offen offset:1024 lds
  s_add_u32 m0, s71, 65536
  s_add_u32 s74, s82, 16384
  buffer_load_dwordx4 v193, s[20:23], s74 offen lds
  s_add_u32 s74, s82, 23552
  buffer_load_dwordx4 v194, s[20:23], s74 offen offset:1024 lds
  ds_read_b64_tr_b16 v[0:1], v215 offset:16384
  ds_read_b64_tr_b16 v[2:3], v215 offset:17408
  ds_read_b64_tr_b16 v[4:5], v216 offset:16384
  ds_read_b64_tr_b16 v[6:7], v216 offset:17408
  s_waitcnt vmcnt(14)
  ds_read_b64_tr_b16 v[8:9], v212 offset:16384
  ds_read_b64_tr_b16 v[10:11], v212 offset:17408
  ds_read_b64_tr_b16 v[12:13], v213 offset:16384
  ds_read_b64_tr_b16 v[14:15], v213 offset:17408
  s_waitcnt lgkmcnt(0)
  s_add_u32 m0, s71, 16384
  s_add_u32 s74, s82, 32768
  buffer_load_dwordx4 v193, s[20:23], s74 offen lds
  s_add_u32 s74, s82, 39936
  buffer_load_dwordx4 v194, s[20:23], s74 offen offset:1024 lds
  s_add_u32 m0, s71, 81920
  s_add_u32 s74, s82, 49152
  buffer_load_dwordx4 v193, s[20:23], s74 offen lds
  s_add_u32 s74, s82, 56320
  buffer_load_dwordx4 v194, s[20:23], s74 offen offset:1024 lds
  s_waitcnt vmcnt(16)
  ds_read_b64_tr_b16 v[16:17], v217 offset:0
  ds_read_b64_tr_b16 v[18:19], v217 offset:1024
  ds_read_b64_tr_b16 v[20:21], v221 offset:0
  ds_read_b64_tr_b16 v[22:23], v221 offset:1024
  s_waitcnt vmcnt(14)
  ds_read_b64_tr_b16 v[24:25], v215 offset:32768
  ds_read_b64_tr_b16 v[26:27], v215 offset:33792
  ds_read_b64_tr_b16 v[28:29], v216 offset:32768
  ds_read_b64_tr_b16 v[30:31], v216 offset:33792
  s_waitcnt vmcnt(12)
  ds_read_b64_tr_b16 v[32:33], v212 offset:32768
  ds_read_b64_tr_b16 v[34:35], v212 offset:33792
  ds_read_b64_tr_b16 v[36:37], v213 offset:32768
  ds_read_b64_tr_b16 v[38:39], v213 offset:33792
  s_waitcnt lgkmcnt(0)
  s_add_u32 m0, s71, 32768
  s_add_u32 s74, s83, 0
  buffer_load_dwordx4 v193, s[20:23], s74 offen lds
  s_add_u32 s74, s83, 7168
  buffer_load_dwordx4 v194, s[20:23], s74 offen offset:1024 lds
  s_add_u32 m0, s71, 98304
  s_add_u32 s74, s83, 16384
  buffer_load_dwordx4 v193, s[20:23], s74 offen lds
  s_add_u32 s74, s83, 23552
  buffer_load_dwordx4 v194, s[20:23], s74 offen offset:1024 lds
  v_and_b32 v210, 15, v220
  v_lshlrev_b32 v210, 2, v210
  buffer_load_dword v210, v210, s[28:31], s45 offen sc1
  s_waitcnt vmcnt(15)
  ds_read_b64_tr_b16 v[40:41], v215 offset:49152
  ds_read_b64_tr_b16 v[42:43], v215 offset:50176
  ds_read_b64_tr_b16 v[44:45], v216 offset:49152
  ds_read_b64_tr_b16 v[46:47], v216 offset:50176
  s_waitcnt vmcnt(13)
  ds_read_b64_tr_b16 v[48:49], v212 offset:49152
  ds_read_b64_tr_b16 v[50:51], v212 offset:50176
  ds_read_b64_tr_b16 v[52:53], v213 offset:49152
  ds_read_b64_tr_b16 v[54:55], v213 offset:50176
  s_waitcnt lgkmcnt(0)
  s_add_u32 m0, s71, 49152
  s_add_u32 s74, s83, 32768
  buffer_load_dwordx4 v193, s[20:23], s74 offen lds
  s_add_u32 s74, s83, 39936
  buffer_load_dwordx4 v194, s[20:23], s74 offen offset:1024 lds
  s_add_u32 m0, s71, 114688
  s_add_u32 s74, s83, 49152
  buffer_load_dwordx4 v193, s[20:23], s74 offen lds
  s_add_u32 s74, s83, 56320
  buffer_load_dwordx4 v194, s[20:23], s74 offen offset:1024 lds
  v_and_b32 v244, 15, v220
  v_lshrrev_b32 v245, 5, v220
  v_lshrrev_b32 v246, 1, v244
  v_xor_b32 v246, v245, v246
  v_lshl_add_u32 v244, v244, 7, s71
  v_lshl_add_u32 v244, v246, 4, v244
  v_bfe_u32 v246, v220, 4, 1
  v_lshl_add_u32 v244, v246, 16, v244
  s_add_u32 s3, s99, 0
  s_and_b32 s3, s3, 3
  s_lshl_b32 s76, s3, 10
  s_lshl_b32 s3, s3, 5
  v_xor_b32 v202, s3, v244
  s_add_u32 s3, s99, 1
  s_and_b32 s3, s3, 3
  s_lshl_b32 s77, s3, 10
  s_lshl_b32 s3, s3, 5
  v_xor_b32 v203, s3, v244
  s_add_u32 s3, s99, 2
  s_and_b32 s3, s3, 3
  s_lshl_b32 s78, s3, 10
  s_lshl_b32 s3, s3, 5
  v_xor_b32 v204, s3, v244
  s_add_u32 s3, s99, 3
  s_and_b32 s3, s3, 3
  s_lshl_b32 s79, s3, 10
  s_lshl_b32 s3, s3, 5
  v_xor_b32 v205, s3, v244
  v_and_b32 v246, 7, v220
  v_xor_b32 v245, v245, v246
  v_lshl_add_u32 v244, v246, 8, s71
  v_lshl_add_u32 v244, v245, 4, v244
  v_bfe_u32 v246, v220, 3, 2
  v_lshl_add_u32 v222, v246, 14, v244
  v_xor_b32 v223, 32, v222
  v_xor_b32 v224, 64, v222
  v_xor_b32 v225, 96, v222
  v_add_u32 v226, 0x10000, v222
  v_add_u32 v227, 0x10000, v223
  v_add_u32 v228, 0x10000, v224
  v_add_u32 v229, 0x10000, v225
  s_waitcnt vmcnt(4)
  s_mov_b32 s94, 0
L21:
  v_cmp_gt_i32 vcc, 3, v210
  s_add_u32 s94, s94, 1
  s_nop 2
  s_and_b32 s3, vcc_lo, 0xffff
  s_cbranch_scc0 L20
  s_cmp_ge_u32 s94, 0x8000
  s_cbranch_scc1 L20
  s_sleep 2
  v_and_b32 v210, 15, v220
  v_lshlrev_b32 v210, 2, v210
  buffer_load_dword v210, v210, s[28:31], s45 offen sc1
  s_waitcnt vmcnt(0)
  s_branch L21
L20:
  s_add_u32 s74, s101, s38
  buffer_load_dwordx4 v[128:131], v219, s[28:31], s74 offen sc1
  buffer_load_dwordx4 v[132:135], v214, s[28:31], s74 offen sc1
  s_add_u32 s74, s101, s39
  buffer_load_dwordx4 v[136:139], v219, s[28:31], s74 offen sc1
  buffer_load_dwordx4 v[140:143], v214, s[28:31], s74 offen sc1
  s_add_u32 s74, s101, s40
  buffer_load_dwordx4 v[144:147], v219, s[28:31], s74 offen sc1
  buffer_load_dwordx4 v[148:151], v214, s[28:31], s74 offen sc1
  s_add_u32 s74, s101, s41
  buffer_load_dwordx4 v[152:155], v219, s[28:31], s74 offen sc1
  buffer_load_dwordx4 v[156:159], v214, s[28:31], s74 offen sc1
  s_add_u32 s74, s101, s42
  buffer_load_dwordx4 v[160:163], v219, s[28:31], s74 offen sc1
  buffer_load_dwordx4 v[164:167], v214, s[28:31], s74 offen sc1
  v_and_b32 v242, 31, v220
  v_lshlrev_b32 v242, 2, v242
  s_lshl_b32 s3, s98, 8
  s_add_u32 s3, s3, 12648448
  buffer_load_dword v206, v242, s[28:31], s3 offen offset:0 sc1
  buffer_load_dword v207, v242, s[28:31], s3 offen offset:128 sc1
  s_lshl_b32 s74, s4, 2
  v_lshrrev_b32 v242, 4, v220
  v_add_u32 v242, s74, v242
  v_lshlrev_b32 v243, 2, v242
  buffer_load_dword v208, v243, s[28:31], s3 offen offset:0 sc1
  buffer_load_dword v209, v243, s[28:31], s3 offen offset:128 sc1
  v_and_b32 v243, 4, v242
  v_lshlrev_b32 v243, 2, v243
  v_and_or_b32 v243, v242, 3, v243
  v_lshrrev_b32 v244, 3, v242
  v_lshl_or_b32 v243, v244, 2, v243
  s_lshl_b32 s3, s98, 6
  v_add_u32 v243, s3, v243
  v_and_b32 v244, 15, v220
  s_lshl_b32 s3, s99, 4
  v_add_u32 v245, s3, v244
  v_lshlrev_b32 v245, 3, v245
  v_lshl_add_u32 v243, v243, 10, v245
  global_load_dwordx2 v[246:247], v245, s[52:53]
  global_load_dwordx2 v[248:249], v243, s[36:37]
  v_add_u32 v245, 0x8000, v243
  global_load_dwordx2 v[250:251], v245, s[36:37]
  v_lshlrev_b32 v210, 1, v243
  v_and_b32 v245, 7, v242
  v_xor_b32 v244, v244, v245
  v_lshlrev_b32 v244, 4, v244
  v_lshl_add_u32 v244, v245, 8, v244
  v_lshrrev_b32 v242, 3, v242
  v_lshl_add_u32 v211, v242, 14, v244
  s_waitcnt vmcnt(15)
  v_mfma_f32_32x32x16_bf16 v[64:79], v[0:3], v[128:131], v[64:79]
  v_mfma_f32_32x32x16_bf16 v[80:95], v[0:3], v[132:135], v[80:95]
  v_mfma_f32_32x32x16_bf16 v[96:111], v[4:7], v[128:131], v[96:111]
  v_mfma_f32_32x32x16_bf16 v[112:127], v[4:7], v[132:135], v[112:127]
  s_add_u32 s74, s101, s43
  buffer_load_dwordx4 v[128:131], v219, s[28:31], s74 offen sc1
  buffer_load_dwordx4 v[132:135], v214, s[28:31], s74 offen sc1
  s_waitcnt vmcnt(15)
  v_mfma_f32_32x32x16_bf16 v[64:79], v[8:11], v[136:139], v[64:79]
  v_mfma_f32_32x32x16_bf16 v[80:95], v[8:11], v[140:143], v[80:95]
  v_mfma_f32_32x32x16_bf16 v[96:111], v[12:15], v[136:139], v[96:111]
  v_mfma_f32_32x32x16_bf16 v[112:127], v[12:15], v[140:143], v[112:127]
  s_add_u32 s74, s101, s44
  buffer_load_dwordx4 v[136:139], v219, s[28:31], s74 offen sc1
  buffer_load_dwordx4 v[140:143], v214, s[28:31], s74 offen sc1
  s_waitcnt vmcnt(15)
  v_mfma_f32_32x32x16_bf16 v[64:79], v[16:19], v[144:147], v[64:79]
  v_mfma_f32_32x32x16_bf16 v[80:95], v[16:19], v[148:151], v[80:95]
  v_mfma_f32_32x32x16_bf16 v[96:111], v[20:23], v[144:147], v[96:111]
  v_mfma_f32_32x32x16_bf16 v[112:127], v[20:23], v[148:151], v[112:127]
  s_add_u32 s74, s80, s76
  buffer_load_dwordx4 v[144:147], v219, s[28:31], s74 offen sc1
  buffer_load_dwordx4 v[148:151], v214, s[28:31], s74 offen sc1
  s_waitcnt vmcnt(15)
  v_mfma_f32_32x32x16_bf16 v[64:79], v[24:27], v[152:155], v[64:79]
  v_mfma_f32_32x32x16_bf16 v[80:95], v[24:27], v[156:159], v[80:95]
  v_mfma_f32_32x32x16_bf16 v[96:111], v[28:31], v[152:155], v[96:111]
  v_mfma_f32_32x32x16_bf16 v[112:127], v[28:31], v[156:159], v[112:127]
  s_add_u32 s74, s80, s77
  buffer_load_dwordx4 v[152:155], v219, s[28:31], s74 offen sc1
  buffer_load_dwordx4 v[156:159], v214, s[28:31], s74 offen sc1
  s_waitcnt vmcnt(15)
  v_mfma_f32_32x32x16_bf16 v[64:79], v[32:35], v[160:163], v[64:79]
  v_mfma_f32_32x32x16_bf16 v[80:95], v[32:35], v[164:167], v[80:95]
  v_mfma_f32_32x32x16_bf16 v[96:111], v[36:39], v[160:163], v[96:111]
  v_mfma_f32_32x32x16_bf16 v[112:127], v[36:39], v[164:167], v[112:127]
  s_add_u32 s74, s80, s78
  buffer_load_dwordx4 v[160:163], v219, s[28:31], s74 offen sc1
  buffer_load_dwordx4 v[164:167], v214, s[28:31], s74 offen sc1
  s_waitcnt vmcnt(8)
  v_mfma_f32_32x32x16_bf16 v[64:79], v[40:43], v[128:131], v[64:79]
  v_mfma_f32_32x32x16_bf16 v[80:95], v[40:43], v[132:135], v[80:95]
  v_mfma_f32_32x32x16_bf16 v[96:111], v[44:47], v[128:131], v[96:111]
  v_mfma_f32_32x32x16_bf16 v[112:127], v[44:47], v[132:135], v[112:127]
  s_add_u32 s74, s80, s79
  buffer_load_dwordx4 v[128:131], v219, s[28:31], s74 offen sc1
  buffer_load_dwordx4 v[132:135], v214, s[28:31], s74 offen sc1
  s_waitcnt vmcnt(8)
  v_mfma_f32_32x32x16_bf16 v[64:79], v[48:51], v[136:139], v[64:79]
  ds_read_b128 v[176:179], v202 offset:0
  ds_read_b128 v[180:183], v202 offset:16384
  v_mfma_f32_32x32x16_bf16 v[80:95], v[48:51], v[140:143], v[80:95]
  v_mfma_f32_32x32x16_bf16 v[96:111], v[52:55], v[136:139], v[96:111]
  v_mfma_f32_32x32x16_bf16 v[112:127], v[52:55], v[140:143], v[112:127]
  s_waitcnt lgkmcnt(0)
  s_add_u32 s74, s81, s76
  buffer_load_dwordx4 v[136:139], v219, s[28:31], s74 offen sc1
  buffer_load_dwordx4 v[140:143], v214, s[28:31], s74 offen sc1
  s_waitcnt vmcnt(8)
  v_mfma_f32_32x32x16_bf16 v[0:15], v[176:179], v[144:147], 0
  ds_read_b128 v[184:187], v203 offset:0
  ds_read_b128 v[188:191], v203 offset:16384
  v_mfma_f32_32x32x16_bf16 v[16:31], v[176:179], v[148:151], 0
  v_mfma_f32_32x32x16_bf16 v[32:47], v[180:183], v[144:147], 0
  v_mfma_f32_32x32x16_bf16 v[48:63], v[180:183], v[148:151], 0
  s_waitcnt lgkmcnt(0)
  s_add_u32 s74, s81, s77
  buffer_load_dwordx4 v[144:147], v219, s[28:31], s74 offen sc1
  buffer_load_dwordx4 v[148:151], v214, s[28:31], s74 offen sc1
  s_waitcnt vmcnt(8)
  v_mfma_f32_32x32x16_bf16 v[0:15], v[184:187], v[152:155], v[0:15]
  ds_read_b128 v[176:179], v204 offset:0
  ds_read_b128 v[180:183], v204 offset:16384
  v_sub_f32 v252, 1.0, v206
  v_cvt_pk_bf16_f32 v252, v252, v252
  v_lshlrev_b32 v252, 16, v252
  v_sub_f32 v253, 1.0, v207
  v_mfma_f32_32x32x16_bf16 v[16:31], v[184:187], v[156:159], v[16:31]
  v_cvt_pk_bf16_f32 v253, v253, v253
  v_lshlrev_b32 v253, 16, v253
  v_mul_f32 v64, v252, v64
  v_mul_f32 v65, v252, v65
  v_mul_f32 v66, v252, v66
  v_mfma_f32_32x32x16_bf16 v[32:47], v[188:191], v[152:155], v[32:47]
  v_mul_f32 v67, v252, v67
  v_mul_f32 v68, v252, v68
  v_mul_f32 v69, v252, v69
  v_mul_f32 v70, v252, v70
  v_mul_f32 v71, v252, v71
  v_mfma_f32_32x32x16_bf16 v[48:63], v[188:191], v[156:159], v[48:63]
  v_mul_f32 v72, v252, v72
  v_mul_f32 v73, v252, v73
  v_mul_f32 v74, v252, v74
  v_mul_f32 v75, v252, v75
  v_mul_f32 v76, v252, v76
  s_waitcnt lgkmcnt(0)
  s_add_u32 s74, s81, s78
  buffer_load_dwordx4 v[152:155], v219, s[28:31], s74 offen sc1
  buffer_load_dwordx4 v[156:159], v214, s[28:31], s74 offen sc1
  s_waitcnt vmcnt(8)
  v_mfma_f32_32x32x16_bf16 v[0:15], v[176:179], v[160:163], v[0:15]
  ds_read_b128 v[184:187], v205 offset:0
  ds_read_b128 v[188:191], v205 offset:16384
  v_mul_f32 v77, v252, v77
  v_mul_f32 v78, v252, v78
  v_mul_f32 v79, v252, v79
  v_mul_f32 v80, v253, v80
  v_mul_f32 v81, v253, v81
  v_mfma_f32_32x32x16_bf16 v[16:31], v[176:179], v[164:167], v[16:31]
  v_mul_f32 v82, v253, v82
  v_mul_f32 v83, v253, v83
  v_mul_f32 v84, v253, v84
  v_mul_f32 v85, v253, v85
  v_mul_f32 v86, v253, v86
  v_mfma_f32_32x32x16_bf16 v[32:47], v[180:183], v[160:163], v[32:47]
  v_mul_f32 v87, v253, v87
  v_mul_f32 v88, v253, v88
  v_mul_f32 v89, v253, v89
  v_mul_f32 v90, v253, v90
  v_mul_f32 v91, v253, v91
  v_mfma_f32_32x32x16_bf16 v[48:63], v[180:183], v[164:167], v[48:63]
  v_mul_f32 v92, v253, v92
  v_mul_f32 v93, v253, v93
  v_mul_f32 v94, v253, v94
  v_mul_f32 v95, v253, v95
  v_mul_f32 v96, v252, v96
  s_waitcnt lgkmcnt(0)
  s_add_u32 s74, s81, s79
  buffer_load_dwordx4 v[160:163], v219, s[28:31], s74 offen sc1
  buffer_load_dwordx4 v[164:167], v214, s[28:31], s74 offen sc1
  s_waitcnt vmcnt(8)
  v_mfma_f32_32x32x16_bf16 v[0:15], v[184:187], v[128:131], v[0:15]
  ds_read_b128 v[176:179], v202 offset:32768
  ds_read_b128 v[180:183], v202 offset:49152
  v_mul_f32 v97, v252, v97
  v_mul_f32 v98, v252, v98
  v_mul_f32 v99, v252, v99
  v_mul_f32 v100, v252, v100
  v_mul_f32 v101, v252, v101
  v_mfma_f32_32x32x16_bf16 v[16:31], v[184:187], v[132:135], v[16:31]
  v_mul_f32 v102, v252, v102
  v_mul_f32 v103, v252, v103
  v_mul_f32 v104, v252, v104
  v_mul_f32 v105, v252, v105
  v_mul_f32 v106, v252, v106
  v_mfma_f32_32x32x16_bf16 v[32:47], v[188:191], v[128:131], v[32:47]
  v_mul_f32 v107, v252, v107
  v_mul_f32 v108, v252, v108
  v_mul_f32 v109, v252, v109
  v_mul_f32 v110, v252, v110
  v_mul_f32 v111, v252, v111
  v_mfma_f32_32x32x16_bf16 v[48:63], v[188:191], v[132:135], v[48:63]
  v_mul_f32 v112, v253, v112
  v_mul_f32 v113, v253, v113
  v_mul_f32 v114, v253, v114
  v_mul_f32 v115, v253, v115
  v_mul_f32 v116, v253, v116
  s_waitcnt lgkmcnt(0)
  s_waitcnt vmcnt(6)
  v_mfma_f32_32x32x16_bf16 v[0:15], v[176:179], v[136:139], v[0:15]
  ds_read_b128 v[184:187], v203 offset:32768
  ds_read_b128 v[188:191], v203 offset:49152
  v_mul_f32 v117, v253, v117
  v_mul_f32 v118, v253, v118
  v_mul_f32 v119, v253, v119
  v_mul_f32 v120, v253, v120
  v_mul_f32 v121, v253, v121
  v_mfma_f32_32x32x16_bf16 v[16:31], v[176:179], v[140:143], v[16:31]
  v_mul_f32 v122, v253, v122
  v_mul_f32 v123, v253, v123
  v_mul_f32 v124, v253, v124
  v_mul_f32 v125, v253, v125
  v_mul_f32 v126, v253, v126
  v_mfma_f32_32x32x16_bf16 v[32:47], v[180:183], v[136:139], v[32:47]
  v_mul_f32 v127, v253, v127
  v_lshlrev_b32 v242, 16, v248
  v_lshlrev_b32 v243, 16, v246
  v_and_b32 v244, 0xffff0000, v248
  v_and_b32 v245, 0xffff0000, v246
  v_mfma_f32_32x32x16_bf16 v[48:63], v[180:183], v[140:143], v[48:63]
  v_mul_f32 v242, v242, v243
  v_mul_f32 v244, v244, v245
  v_cvt_pk_bf16_f32 v242, v242, v244
  v_lshlrev_b32 v232, 16, v242
  v_and_b32 v233, 0xffff0000, v242
  s_waitcnt lgkmcnt(0)
  s_waitcnt vmcnt(4)
  v_mfma_f32_32x32x16_bf16 v[0:15], v[184:187], v[144:147], v[0:15]
  ds_read_b128 v[176:179], v204 offset:32768
  ds_read_b128 v[180:183], v204 offset:49152
  v_mul_f32 v232, v232, v208
  v_mul_f32 v233, v233, v208
  v_lshlrev_b32 v242, 16, v249
  v_lshlrev_b32 v243, 16, v247
  v_and_b32 v244, 0xffff0000, v249
  v_mfma_f32_32x32x16_bf16 v[16:31], v[184:187], v[148:151], v[16:31]
  v_and_b32 v245, 0xffff0000, v247
  v_mul_f32 v242, v242, v243
  v_mul_f32 v244, v244, v245
  v_cvt_pk_bf16_f32 v242, v242, v244
  v_lshlrev_b32 v234, 16, v242
  v_mfma_f32_32x32x16_bf16 v[32:47], v[188:191], v[144:147], v[32:47]
  v_and_b32 v235, 0xffff0000, v242
  v_mul_f32 v234, v234, v208
  v_mul_f32 v235, v235, v208
  v_lshlrev_b32 v242, 16, v250
  v_lshlrev_b32 v243, 16, v246
  v_mfma_f32_32x32x16_bf16 v[48:63], v[188:191], v[148:151], v[48:63]
  v_and_b32 v244, 0xffff0000, v250
  v_and_b32 v245, 0xffff0000, v246
  v_mul_f32 v242, v242, v243
  v_mul_f32 v244, v244, v245
  v_cvt_pk_bf16_f32 v242, v242, v244
  s_waitcnt lgkmcnt(0)
  s_waitcnt vmcnt(2)
  v_mfma_f32_32x32x16_bf16 v[0:15], v[176:179], v[152:155], v[0:15]
  ds_read_b128 v[184:187], v205 offset:32768
  ds_read_b128 v[188:191], v205 offset:49152
  v_lshlrev_b32 v236, 16, v242
  v_and_b32 v237, 0xffff0000, v242
  v_mul_f32 v236, v236, v209
  v_mul_f32 v237, v237, v209
  v_lshlrev_b32 v242, 16, v251
  v_mfma_f32_32x32x16_bf16 v[16:31], v[176:179], v[156:159], v[16:31]
  v_lshlrev_b32 v243, 16, v247
  v_and_b32 v244, 0xffff0000, v251
  v_and_b32 v245, 0xffff0000, v247
  v_mul_f32 v242, v242, v243
  v_mul_f32 v244, v244, v245
  v_mfma_f32_32x32x16_bf16 v[32:47], v[180:183], v[152:155], v[32:47]
  v_cvt_pk_bf16_f32 v242, v242, v244
  v_lshlrev_b32 v238, 16, v242
  v_and_b32 v239, 0xffff0000, v242
  v_mul_f32 v238, v238, v209
  v_mul_f32 v239, v239, v209
  v_mfma_f32_32x32x16_bf16 v[48:63], v[180:183], v[156:159], v[48:63]
  v_add_u32 v242, 0x10000, v211
  s_waitcnt lgkmcnt(0)
  s_waitcnt vmcnt(0)
  v_mfma_f32_32x32x16_bf16 v[0:15], v[184:187], v[160:163], v[0:15]
  v_mfma_f32_32x32x16_bf16 v[16:31], v[184:187], v[164:167], v[16:31]
  v_mfma_f32_32x32x16_bf16 v[32:47], v[188:191], v[160:163], v[32:47]
  v_mfma_f32_32x32x16_bf16 v[48:63], v[188:191], v[164:167], v[48:63]
  s_mov_b32 s24, s64
  s_mov_b32 s25, s65
  s_mov_b32 s26, 4194304
  s_mov_b32 s27, 0x20000
  s_nop 7
  v_pk_fma_f32 v[64:65], v[206:207], v[0:1], v[64:65] op_sel:[0,0,0] op_sel_hi:[0,1,1]
  v_pk_fma_f32 v[66:67], v[206:207], v[2:3], v[66:67] op_sel:[0,0,0] op_sel_hi:[0,1,1]
  ds_write_b128 v222, v[64:67] offset:0
  v_pk_fma_f32 v[68:69], v[206:207], v[4:5], v[68:69] op_sel:[0,0,0] op_sel_hi:[0,1,1]
  v_pk_fma_f32 v[70:71], v[206:207], v[6:7], v[70:71] op_sel:[0,0,0] op_sel_hi:[0,1,1]
  ds_write_b128 v223, v[68:71] offset:0
  v_pk_fma_f32 v[72:73], v[206:207], v[8:9], v[72:73] op_sel:[0,0,0] op_sel_hi:[0,1,1]
  v_pk_fma_f32 v[74:75], v[206:207], v[10:11], v[74:75] op_sel:[0,0,0] op_sel_hi:[0,1,1]
  ds_write_b128 v224, v[72:75] offset:0
  v_pk_fma_f32 v[76:77], v[206:207], v[12:13], v[76:77] op_sel:[0,0,0] op_sel_hi:[0,1,1]
  v_pk_fma_f32 v[78:79], v[206:207], v[14:15], v[78:79] op_sel:[0,0,0] op_sel_hi:[0,1,1]
  ds_write_b128 v225, v[76:79] offset:0
  v_pk_fma_f32 v[80:81], v[206:207], v[16:17], v[80:81] op_sel:[1,0,0] op_sel_hi:[1,1,1]
  v_pk_fma_f32 v[82:83], v[206:207], v[18:19], v[82:83] op_sel:[1,0,0] op_sel_hi:[1,1,1]
  ds_write_b128 v226, v[80:83] offset:0
  v_pk_fma_f32 v[84:85], v[206:207], v[20:21], v[84:85] op_sel:[1,0,0] op_sel_hi:[1,1,1]
  v_pk_fma_f32 v[86:87], v[206:207], v[22:23], v[86:87] op_sel:[1,0,0] op_sel_hi:[1,1,1]
  ds_write_b128 v227, v[84:87] offset:0
  v_pk_fma_f32 v[88:89], v[206:207], v[24:25], v[88:89] op_sel:[1,0,0] op_sel_hi:[1,1,1]
  v_pk_fma_f32 v[90:91], v[206:207], v[26:27], v[90:91] op_sel:[1,0,0] op_sel_hi:[1,1,1]
  ds_write_b128 v228, v[88:91] offset:0
  v_pk_fma_f32 v[92:93], v[206:207], v[28:29], v[92:93] op_sel:[1,0,0] op_sel_hi:[1,1,1]
  v_pk_fma_f32 v[94:95], v[206:207], v[30:31], v[94:95] op_sel:[1,0,0] op_sel_hi:[1,1,1]
  ds_write_b128 v229, v[92:95] offset:0
  v_pk_fma_f32 v[96:97], v[206:207], v[32:33], v[96:97] op_sel:[0,0,0] op_sel_hi:[0,1,1]
  v_pk_fma_f32 v[98:99], v[206:207], v[34:35], v[98:99] op_sel:[0,0,0] op_sel_hi:[0,1,1]
  ds_write_b128 v222, v[96:99] offset:128
  v_pk_fma_f32 v[100:101], v[206:207], v[36:37], v[100:101] op_sel:[0,0,0] op_sel_hi:[0,1,1]
  v_pk_fma_f32 v[102:103], v[206:207], v[38:39], v[102:103] op_sel:[0,0,0] op_sel_hi:[0,1,1]
  ds_write_b128 v223, v[100:103] offset:128
  v_pk_fma_f32 v[104:105], v[206:207], v[40:41], v[104:105] op_sel:[0,0,0] op_sel_hi:[0,1,1]
  v_pk_fma_f32 v[106:107], v[206:207], v[42:43], v[106:107] op_sel:[0,0,0] op_sel_hi:[0,1,1]
  ds_write_b128 v224, v[104:107] offset:128
  v_pk_fma_f32 v[108:109], v[206:207], v[44:45], v[108:109] op_sel:[0,0,0] op_sel_hi:[0,1,1]
  v_pk_fma_f32 v[110:111], v[206:207], v[46:47], v[110:111] op_sel:[0,0,0] op_sel_hi:[0,1,1]
  ds_write_b128 v225, v[108:111] offset:128
  v_pk_fma_f32 v[112:113], v[206:207], v[48:49], v[112:113] op_sel:[1,0,0] op_sel_hi:[1,1,1]
  v_pk_fma_f32 v[114:115], v[206:207], v[50:51], v[114:115] op_sel:[1,0,0] op_sel_hi:[1,1,1]
  ds_write_b128 v226, v[112:115] offset:128
  v_pk_fma_f32 v[116:117], v[206:207], v[52:53], v[116:117] op_sel:[1,0,0] op_sel_hi:[1,1,1]
  v_pk_fma_f32 v[118:119], v[206:207], v[54:55], v[118:119] op_sel:[1,0,0] op_sel_hi:[1,1,1]
  ds_write_b128 v227, v[116:119] offset:128
  v_pk_fma_f32 v[120:121], v[206:207], v[56:57], v[120:121] op_sel:[1,0,0] op_sel_hi:[1,1,1]
  v_pk_fma_f32 v[122:123], v[206:207], v[58:59], v[122:123] op_sel:[1,0,0] op_sel_hi:[1,1,1]
  ds_write_b128 v228, v[120:123] offset:128
  v_pk_fma_f32 v[124:125], v[206:207], v[60:61], v[124:125] op_sel:[1,0,0] op_sel_hi:[1,1,1]
  v_pk_fma_f32 v[126:127], v[206:207], v[62:63], v[126:127] op_sel:[1,0,0] op_sel_hi:[1,1,1]
  ds_write_b128 v229, v[124:127] offset:128
  s_waitcnt lgkmcnt(0)
  s_barrier
  ds_read_b128 v[0:3], v211 offset:0
  ds_read_b128 v[4:7], v211 offset:2048
  ds_read_b128 v[8:11], v211 offset:4096
  ds_read_b128 v[12:15], v211 offset:6144
  ds_read_b128 v[16:19], v211 offset:8192
  ds_read_b128 v[20:23], v211 offset:10240
  ds_read_b128 v[24:27], v211 offset:12288
  ds_read_b128 v[28:31], v211 offset:14336
  ds_read_b128 v[32:35], v242 offset:0
  ds_read_b128 v[36:39], v242 offset:2048
  ds_read_b128 v[40:43], v242 offset:4096
  ds_read_b128 v[44:47], v242 offset:6144
  ds_read_b128 v[48:51], v242 offset:8192
  ds_read_b128 v[52:55], v242 offset:10240
  ds_read_b128 v[56:59], v242 offset:12288
  ds_read_b128 v[60:63], v242 offset:14336
  s_waitcnt lgkmcnt(15)
  v_pk_add_f32 v[232:233], v[232:233], v[0:1]
  v_pk_add_f32 v[234:235], v[234:235], v[2:3]
  s_waitcnt lgkmcnt(14)
  v_pk_add_f32 v[232:233], v[232:233], v[4:5]
  v_pk_add_f32 v[234:235], v[234:235], v[6:7]
  s_waitcnt lgkmcnt(13)
  v_pk_add_f32 v[232:233], v[232:233], v[8:9]
  v_pk_add_f32 v[234:235], v[234:235], v[10:11]
  s_waitcnt lgkmcnt(12)
  v_pk_add_f32 v[232:233], v[232:233], v[12:13]
  v_pk_add_f32 v[234:235], v[234:235], v[14:15]
  s_waitcnt lgkmcnt(11)
  v_pk_add_f32 v[232:233], v[232:233], v[16:17]
  v_pk_add_f32 v[234:235], v[234:235], v[18:19]
  s_waitcnt lgkmcnt(10)
  v_pk_add_f32 v[232:233], v[232:233], v[20:21]
  v_pk_add_f32 v[234:235], v[234:235], v[22:23]
  s_waitcnt lgkmcnt(9)
  v_pk_add_f32 v[232:233], v[232:233], v[24:25]
  v_pk_add_f32 v[234:235], v[234:235], v[26:27]
  s_waitcnt lgkmcnt(8)
  v_pk_add_f32 v[232:233], v[232:233], v[28:29]
  v_pk_add_f32 v[234:235], v[234:235], v[30:31]
  s_mov_b32 s3, 0
  buffer_store_dwordx4 v[232:235], v210, s[24:27], s3 offen sc1
  s_waitcnt lgkmcnt(7)
  v_pk_add_f32 v[236:237], v[236:237], v[32:33]
  v_pk_add_f32 v[238:239], v[238:239], v[34:35]
  s_waitcnt lgkmcnt(6)
  v_pk_add_f32 v[236:237], v[236:237], v[36:37]
  v_pk_add_f32 v[238:239], v[238:239], v[38:39]
  s_waitcnt lgkmcnt(5)
  v_pk_add_f32 v[236:237], v[236:237], v[40:41]
  v_pk_add_f32 v[238:239], v[238:239], v[42:43]
  s_waitcnt lgkmcnt(4)
  v_pk_add_f32 v[236:237], v[236:237], v[44:45]
  v_pk_add_f32 v[238:239], v[238:239], v[46:47]
  s_waitcnt lgkmcnt(3)
  v_pk_add_f32 v[236:237], v[236:237], v[48:49]
  v_pk_add_f32 v[238:239], v[238:239], v[50:51]
  s_waitcnt lgkmcnt(2)
  v_pk_add_f32 v[236:237], v[236:237], v[52:53]
  v_pk_add_f32 v[238:239], v[238:239], v[54:55]
  s_waitcnt lgkmcnt(1)
  v_pk_add_f32 v[236:237], v[236:237], v[56:57]
  v_pk_add_f32 v[238:239], v[238:239], v[58:59]
  s_waitcnt lgkmcnt(0)
  v_pk_add_f32 v[236:237], v[236:237], v[60:61]
  v_pk_add_f32 v[238:239], v[238:239], v[62:63]
  s_mov_b32 s3, 65536
  buffer_store_dwordx4 v[236:239], v210, s[24:27], s3 offen sc1
Lexit:
  s_endpgm
Lzpath:
  s_waitcnt vmcnt(4) lgkmcnt(0)
  s_barrier
  s_cmp_lg_u32 s6, 15
  s_cbranch_scc1 L22
  s_cmp_lg_u32 s4, 0
  s_cbranch_scc1 L22
  s_lshl_b32 s3, s5, 2
  v_mov_b32 v1, s3
  v_mov_b32 v2, 1
  s_mov_b64 exec, 1
  global_store_dword v1, v2, s[66:67] sc1
  s_mov_b64 exec, -1
L22:
  ds_read_b128 v[0:3], v208 offset:0
  ds_read_b128 v[4:7], v209 offset:0
  s_waitcnt lgkmcnt(0)
  ds_read_b128 v[8:11], v210 offset:0
  ds_read_b128 v[12:15], v211 offset:0
  s_add_u32 m0, s71, 32768
  s_nop 0
  buffer_load_dwordx4 v214, s[8:11], s40 offen lds
  buffer_load_dwordx4 v215, s[8:11], s40 offen offset:1024 lds
  s_waitcnt lgkmcnt(0)
  s_waitcnt vmcnt(2) lgkmcnt(0)
  s_barrier
  ds_read_b128 v[16:19], v208 offset:16384
  ds_read_b128 v[20:23], v209 offset:16384
  s_add_u32 m0, s71, 49152
  s_nop 0
  buffer_load_dwordx4 v214, s[8:11], s41 offen lds
  buffer_load_dwordx4 v215, s[8:11], s41 offen offset:1024 lds
  s_cmp_lg_u32 s4, 2
  s_cbranch_scc1 L23
  s_lshl_b32 s3, s2, 4
  v_min_u32 v252, 15, v220
  v_add_u32 v252, s3, v252
  v_lshlrev_b32 v252, 7, v252
  s_mov_b32 m0, 151552
  s_nop 0
  global_load_lds_dword v252, s[20:21]
L23:
  s_waitcnt lgkmcnt(0)
  ds_read_b128 v[24:27], v210 offset:16384
  ds_read_b128 v[28:31], v211 offset:16384
  s_cmp_lg_u32 s4, 3
  s_cbranch_scc1 L24
  s_lshl_b32 s3, s2, 4
  v_min_u32 v252, 15, v220
  v_add_u32 v252, s3, v252
  v_lshlrev_b32 v252, 7, v252
  s_mov_b32 m0, 151552
  s_nop 0
  global_load_lds_dword v252, s[24:25]
L24:
  s_waitcnt lgkmcnt(0)
  s_waitcnt vmcnt(2) lgkmcnt(0)
  s_barrier
  ds_read_b128 v[32:35], v208 offset:32768
  ds_read_b128 v[36:39], v209 offset:32768
  s_add_u32 m0, s71, 0
  s_nop 0
  buffer_load_dwordx4 v214, s[8:11], s42 offen lds
  buffer_load_dwordx4 v215, s[8:11], s42 offen offset:1024 lds
  s_waitcnt lgkmcnt(0)
  ds_read_b128 v[40:43], v210 offset:32768
  ds_read_b128 v[44:47], v211 offset:32768
  s_waitcnt lgkmcnt(0)
  s_waitcnt vmcnt(2) lgkmcnt(0)
  s_barrier
  ds_read_b128 v[48:51], v208 offset:49152
  ds_read_b128 v[52:55], v209 offset:49152
  s_add_u32 m0, s71, 16384
  s_nop 0
  buffer_load_dwordx4 v214, s[8:11], s43 offen lds
  buffer_load_dwordx4 v215, s[8:11], s43 offen offset:1024 lds
  s_cmp_lg_u32 s4, 0
  s_cbranch_scc1 L25
  s_mul_i32 s3, s2, 28
  v_min_u32 v252, 27, v220
  v_add_u32 v252, s3, v252
  v_lshlrev_b32 v252, 8, v252
  v_add_u32 v252, 128, v252
  s_mov_b32 m0, 151552
  s_nop 0
  global_load_lds_dword v252, s[12:13]
L25:
  s_waitcnt lgkmcnt(0)
  ds_read_b128 v[56:59], v210 offset:49152
  ds_read_b128 v[60:63], v211 offset:49152
  s_cmp_lg_u32 s4, 1
  s_cbranch_scc1 L26
  s_mul_i32 s3, s2, 28
  s_add_u32 s3, s3, 4
  v_min_u32 v252, 27, v220
  v_add_u32 v252, s3, v252
  v_lshlrev_b32 v252, 8, v252
  v_add_u32 v252, 128, v252
  s_mov_b32 m0, 151552
  s_nop 0
  global_load_lds_dword v252, s[16:17]
L26:
  s_waitcnt lgkmcnt(0)
  s_waitcnt vmcnt(2) lgkmcnt(0)
  s_barrier
  ds_read_b128 v[64:67], v208 offset:0
  ds_read_b128 v[68:71], v209 offset:0
  s_add_u32 m0, s71, 32768
  s_nop 0
  buffer_load_dwordx4 v214, s[8:11], s44 offen lds
  buffer_load_dwordx4 v215, s[8:11], s44 offen offset:1024 lds
  s_waitcnt lgkmcnt(0)
  ds_read_b128 v[72:75], v210 offset:0
  ds_read_b128 v[76:79], v211 offset:0
  s_waitcnt lgkmcnt(0)
  s_waitcnt vmcnt(2) lgkmcnt(0)
  s_barrier
  ds_read_b128 v[80:83], v208 offset:16384
  ds_read_b128 v[84:87], v209 offset:16384
  s_add_u32 m0, s71, 49152
  s_nop 0
  buffer_load_dwordx4 v214, s[8:11], s45 offen lds
  buffer_load_dwordx4 v215, s[8:11], s45 offen offset:1024 lds
  s_waitcnt lgkmcnt(0)
  ds_read_b128 v[88:91], v210 offset:16384
  ds_read_b128 v[92:95], v211 offset:16384
  s_waitcnt lgkmcnt(0)
  s_waitcnt vmcnt(2) lgkmcnt(0)
  s_barrier
  v_add_u32 v216, 128, v216
  v_add_u32 v217, 128, v217
  ds_read_b128 v[96:99], v208 offset:32768
  ds_read_b128 v[100:103], v209 offset:32768
  s_add_u32 m0, s73, 0
  s_nop 0
  buffer_load_dwordx4 v218, s[20:23], s98 offen lds
  s_add_u32 m0, s73, 4096
  s_nop 0
  buffer_load_dwordx4 v218, s[20:23], s99 offen lds
  s_add_u32 m0, s73, 65536
  s_nop 0
  buffer_load_dwordx4 v218, s[24:27], s98 offen lds
  s_waitcnt lgkmcnt(0)
  ds_read_b128 v[104:107], v210 offset:32768
  ds_read_b128 v[108:111], v211 offset:32768
  s_add_u32 m0, s73, 69632
  s_nop 0
  buffer_load_dwordx4 v218, s[24:27], s99 offen lds
  s_waitcnt lgkmcnt(0)
  s_waitcnt vmcnt(4) lgkmcnt(0)
  s_barrier
  ds_read_b128 v[112:115], v208 offset:49152
  ds_read_b128 v[116:119], v209 offset:49152
  s_add_u32 m0, s73, 16384
  s_nop 0
  buffer_load_dwordx4 v218, s[20:23], s100 offen lds
  s_add_u32 m0, s73, 20480
  s_nop 0
  buffer_load_dwordx4 v218, s[20:23], s101 offen lds
  s_add_u32 m0, s73, 81920
  s_nop 0
  buffer_load_dwordx4 v218, s[24:27], s100 offen lds
  s_waitcnt lgkmcnt(0)
  ds_read_b128 v[120:123], v210 offset:49152
  ds_read_b128 v[124:127], v211 offset:49152
  s_add_u32 m0, s73, 86016
  s_nop 0
  buffer_load_dwordx4 v218, s[24:27], s101 offen lds
  s_cmp_lg_u32 s4, 4
  s_cbranch_scc1 L27
  s_mul_i32 s3, s2, 28
  v_min_u32 v252, 27, v220
  v_add_u32 v252, s3, v252
  v_lshrrev_b32 v254, 9, v252
  v_lshl_add_u32 v252, v254, 9, v252
  v_add_u32 v252, 0, v252
  v_lshlrev_b32 v252, 7, v252
  s_mov_b32 m0, 151552
  s_nop 0
  global_load_lds_dword v252, s[60:61]
L27:
  s_waitcnt lgkmcnt(0)
  s_waitcnt vmcnt(4) lgkmcnt(0)
  s_barrier
  v_and_b32 v250, 15, v220
  v_lshrrev_b32 v251, 5, v220
  v_lshrrev_b32 v208, 1, v250
  v_xor_b32 v251, v251, v208
  s_lshl_b32 s3, s70, 11
  v_lshl_add_u32 v250, v250, 7, s3
  v_lshl_add_u32 v250, v251, 4, v250
  v_bfe_u32 v251, v220, 4, 1
  v_lshl_add_u32 v208, v251, 16, v250
  v_xor_b32 v209, 32, v208
  v_xor_b32 v210, 64, v208
  v_xor_b32 v211, 96, v208
  v_mul_u32_u24 v251, 64512, v251
  v_subrev_u32 v251, 0x10000, v251
  v_lshrrev_b32 v250, 5, v220
  v_lshlrev_b32 v250, 10, v250
  v_sub_u32 v251, v251, v250
  v_add_u32 v212, v212, v251
  v_add_u32 v213, v213, v251
  ds_read_b128 v[176:179], v208 offset:0
  ds_read_b128 v[180:183], v209 offset:0
  ds_read_b128 v[184:187], v210 offset:0
  ds_read_b128 v[188:191], v211 offset:0
  s_cmp_lg_u32 s4, 5
  s_cbranch_scc1 L28
  s_mul_i32 s3, s2, 28
  v_min_u32 v252, 27, v220
  v_add_u32 v252, s3, v252
  v_lshrrev_b32 v254, 9, v252
  v_lshl_add_u32 v252, v254, 9, v252
  v_add_u32 v252, 512, v252
  v_lshlrev_b32 v252, 7, v252
  s_mov_b32 m0, 151552
  s_nop 0
  global_load_lds_dword v252, s[60:61]
L28:
  s_waitcnt lgkmcnt(0)
  v_mfma_f32_32x32x16_bf16 v[160:175], v[0:3], v[176:179], 0
  ds_read_b128 v[192:195], v208 offset:4096
  ds_read_b128 v[196:199], v209 offset:4096
  ds_read_b128 v[200:203], v210 offset:4096
  ds_read_b128 v[204:207], v211 offset:4096
  v_mfma_f32_32x32x16_bf16 v[160:175], v[4:7], v[180:183], v[160:175]
  v_mfma_f32_32x32x16_bf16 v[160:175], v[8:11], v[184:187], v[160:175]
  v_mfma_f32_32x32x16_bf16 v[160:175], v[12:15], v[188:191], v[160:175]
  s_waitcnt lgkmcnt(0)
  v_mfma_f32_32x32x16_bf16 v[160:175], v[16:19], v[192:195], v[160:175]
  ds_read_b128 v[176:179], v208 offset:8192
  ds_read_b128 v[180:183], v209 offset:8192
  ds_read_b128 v[184:187], v210 offset:8192
  ds_read_b128 v[188:191], v211 offset:8192
  v_mfma_f32_32x32x16_bf16 v[160:175], v[20:23], v[196:199], v[160:175]
  v_mfma_f32_32x32x16_bf16 v[160:175], v[24:27], v[200:203], v[160:175]
  v_mfma_f32_32x32x16_bf16 v[160:175], v[28:31], v[204:207], v[160:175]
  s_waitcnt lgkmcnt(0)
  v_mfma_f32_32x32x16_bf16 v[160:175], v[32:35], v[176:179], v[160:175]
  ds_read_b128 v[192:195], v208 offset:12288
  ds_read_b128 v[196:199], v209 offset:12288
  ds_read_b128 v[200:203], v210 offset:12288
  ds_read_b128 v[204:207], v211 offset:12288
  v_mfma_f32_32x32x16_bf16 v[160:175], v[36:39], v[180:183], v[160:175]
  v_mfma_f32_32x32x16_bf16 v[160:175], v[40:43], v[184:187], v[160:175]
  v_mfma_f32_32x32x16_bf16 v[160:175], v[44:47], v[188:191], v[160:175]
  s_waitcnt lgkmcnt(0)
  v_mfma_f32_32x32x16_bf16 v[160:175], v[48:51], v[192:195], v[160:175]
  s_waitcnt vmcnt(0) lgkmcnt(0)
  s_barrier
  v_mfma_f32_32x32x16_bf16 v[160:175], v[52:55], v[196:199], v[160:175]
  ds_read_b128 v[176:179], v208 offset:16384
  ds_read_b128 v[180:183], v209 offset:16384
  ds_read_b128 v[184:187], v210 offset:16384
  ds_read_b128 v[188:191], v211 offset:16384
  s_cmp_lg_u32 s4, 6
  s_cbranch_scc1 L29
  s_lshl_b32 s3, s2, 4
  v_min_u32 v252, 15, v220
  v_add_u32 v252, s3, v252
  v_lshlrev_b32 v252, 7, v252
  s_mov_b32 m0, 151552
  s_nop 0
  global_load_lds_dword v252, s[46:47]
L29:
  v_mfma_f32_32x32x16_bf16 v[160:175], v[56:59], v[200:203], v[160:175]
  s_cmp_lg_u32 s4, 7
  s_cbranch_scc1 L30
  s_lshl_b32 s3, s2, 4
  v_min_u32 v252, 15, v220
  v_add_u32 v252, s3, v252
  v_lshlrev_b32 v252, 7, v252
  s_mov_b32 m0, 151552
  s_nop 0
  global_load_lds_dword v252, s[48:49]
L30:
  v_mfma_f32_32x32x16_bf16 v[160:175], v[60:63], v[204:207], v[160:175]
  s_waitcnt lgkmcnt(0)
  v_and_b32 v215, 15, v220
  v_lshlrev_b32 v215, 2, v215
  global_load_dword v214, v215, s[66:67] sc1
  v_mfma_f32_32x32x16_bf16 v[160:175], v[64:67], v[176:179], v[160:175]
  ds_read_b128 v[192:195], v208 offset:20480
  ds_read_b128 v[196:199], v209 offset:20480
  ds_read_b128 v[200:203], v210 offset:20480
  ds_read_b128 v[204:207], v211 offset:20480
  v_mfma_f32_32x32x16_bf16 v[160:175], v[68:71], v[180:183], v[160:175]
  v_mfma_f32_32x32x16_bf16 v[160:175], v[72:75], v[184:187], v[160:175]
  v_mfma_f32_32x32x16_bf16 v[160:175], v[76:79], v[188:191], v[160:175]
  s_waitcnt lgkmcnt(0)
  v_mfma_f32_32x32x16_bf16 v[160:175], v[80:83], v[192:195], v[160:175]
  ds_read_b128 v[176:179], v208 offset:24576
  ds_read_b128 v[180:183], v209 offset:24576
  ds_read_b128 v[184:187], v210 offset:24576
  ds_read_b128 v[188:191], v211 offset:24576
  v_mfma_f32_32x32x16_bf16 v[160:175], v[84:87], v[196:199], v[160:175]
  v_mfma_f32_32x32x16_bf16 v[160:175], v[88:91], v[200:203], v[160:175]
  v_mfma_f32_32x32x16_bf16 v[160:175], v[92:95], v[204:207], v[160:175]
  s_waitcnt lgkmcnt(0)
  v_mfma_f32_32x32x16_bf16 v[160:175], v[96:99], v[176:179], v[160:175]
  ds_read_b128 v[192:195], v208 offset:28672
  ds_read_b128 v[196:199], v209 offset:28672
  ds_read_b128 v[200:203], v210 offset:28672
  ds_read_b128 v[204:207], v211 offset:28672
  v_mfma_f32_32x32x16_bf16 v[160:175], v[100:103], v[180:183], v[160:175]
  v_mfma_f32_32x32x16_bf16 v[160:175], v[104:107], v[184:187], v[160:175]
  v_mfma_f32_32x32x16_bf16 v[160:175], v[108:111], v[188:191], v[160:175]
  s_waitcnt lgkmcnt(0)
  v_mfma_f32_32x32x16_bf16 v[160:175], v[112:115], v[192:195], v[160:175]
  v_mfma_f32_32x32x16_bf16 v[160:175], v[116:119], v[196:199], v[160:175]
  v_mfma_f32_32x32x16_bf16 v[160:175], v[120:123], v[200:203], v[160:175]
  v_mfma_f32_32x32x16_bf16 v[160:175], v[124:127], v[204:207], v[160:175]
  s_nop 7
  s_nop 3
  v_permlane16_swap_b32 v160, v168
  v_permlane16_swap_b32 v161, v169
  v_permlane16_swap_b32 v162, v170
  v_permlane16_swap_b32 v163, v171
  v_permlane16_swap_b32 v164, v172
  v_permlane16_swap_b32 v165, v173
  v_permlane16_swap_b32 v166, v174
  v_permlane16_swap_b32 v167, v175
  v_mul_f32 v242, v241, v168
  v_mul_f32 v243, v241, v160
  v_fma_f32 v160, v240, v160, -v242
  v_fma_f32 v168, v240, v168, v243
  v_mul_f32 v244, v241, v169
  v_mul_f32 v245, v241, v161
  v_fma_f32 v161, v240, v161, -v244
  v_fma_f32 v169, v240, v169, v245
  v_mul_f32 v242, v241, v170
  v_mul_f32 v243, v241, v162
  v_fma_f32 v162, v240, v162, -v242
  v_fma_f32 v170, v240, v170, v243
  v_mul_f32 v244, v241, v171
  v_mul_f32 v245, v241, v163
  v_fma_f32 v163, v240, v163, -v244
  v_fma_f32 v171, v240, v171, v245
  v_mul_f32 v242, v241, v172
  v_mul_f32 v243, v241, v164
  v_fma_f32 v164, v240, v164, -v242
  v_fma_f32 v172, v240, v172, v243
  v_mul_f32 v244, v241, v173
  v_mul_f32 v245, v241, v165
  v_fma_f32 v165, v240, v165, -v244
  v_fma_f32 v173, v240, v173, v245
  v_mul_f32 v242, v241, v174
  v_mul_f32 v243, v241, v166
  v_fma_f32 v166, v240, v166, -v242
  v_fma_f32 v174, v240, v174, v243
  v_mul_f32 v244, v241, v175
  v_mul_f32 v245, v241, v167
  v_fma_f32 v167, v240, v167, -v244
  v_fma_f32 v175, v240, v175, v245
  v_fma_f32 v244, v222, v160, v161
  v_fma_f32 v245, v222, v168, v169
  v_fma_f32 v244, -v223, v168, v244
  v_fmac_f32 v245, v223, v160
  v_fma_f32 v242, v222, v244, v162
  v_fma_f32 v243, v222, v245, v170
  v_fma_f32 v242, -v223, v245, v242
  v_fmac_f32 v243, v223, v244
  v_fma_f32 v244, v222, v242, v163
  v_fma_f32 v245, v222, v243, v171
  v_fma_f32 v244, -v223, v243, v244
  v_fmac_f32 v245, v223, v242
  v_fma_f32 v242, v222, v244, v164
  v_fma_f32 v243, v222, v245, v172
  v_fma_f32 v242, -v223, v245, v242
  v_fmac_f32 v243, v223, v244
  v_fma_f32 v244, v222, v242, v165
  v_fma_f32 v245, v222, v243, v173
  v_fma_f32 v244, -v223, v243, v244
  v_fmac_f32 v245, v223, v242
  v_fma_f32 v242, v222, v244, v166
  v_fma_f32 v243, v222, v245, v174
  v_fma_f32 v242, -v223, v245, v242
  v_fmac_f32 v243, v223, v244
  v_fma_f32 v244, v222, v242, v167
  v_fma_f32 v245, v222, v243, v175
  v_fma_f32 v244, -v223, v243, v244
  v_fmac_f32 v245, v223, v242
  v_mov_b32 v246, v244
  v_mov_b32 v247, v245
  s_nop 1
  v_permlane16_swap_b32 v246, v244
  v_permlane16_swap_b32 v247, v245
  s_nop 0
  v_fmac_f32 v244, v224, v246
  v_fmac_f32 v245, v224, v247
  v_fma_f32 v244, -v225, v247, v244
  v_fmac_f32 v245, v225, v246
  v_mov_b32 v248, v244
  v_mov_b32 v249, v245
  s_nop 1
  v_permlane32_swap_b32 v248, v244
  v_permlane32_swap_b32 v249, v245
  s_nop 0
  v_fmac_f32 v244, v226, v248
  v_fmac_f32 v245, v226, v249
  v_fma_f32 v244, -v227, v249, v244
  v_fmac_f32 v245, v227, v248
  ds_write_b64 v221, v[244:245]
  v_cndmask_b32 v246, 0, v246, s[76:77]
  v_cndmask_b32 v247, 0, v247, s[76:77]
  v_cndmask_b32 v208, v246, v248, s[78:79]
  v_cndmask_b32 v209, v247, v249, s[78:79]
  v_fmac_f32 v246, v224, v248
  v_fmac_f32 v247, v224, v249
  v_fma_f32 v246, -v225, v249, v246
  v_fmac_f32 v247, v225, v248
  v_cndmask_b32 v208, v208, v246, s[80:81]
  v_cndmask_b32 v209, v209, v247, s[80:81]
  s_waitcnt vmcnt(0)
  s_mov_b32 s94, 0
L32:
  v_cmp_eq_u32 vcc, 0, v214
  s_add_u32 s94, s94, 1
  s_nop 2
  s_and_b32 s3, vcc_lo, 0xffff
  s_cbranch_scc0 L31
  s_cmp_ge_u32 s94, 0x8000
  s_cbranch_scc1 L31
  s_sleep 2
  global_load_dword v214, v215, s[66:67] sc1
  s_waitcnt vmcnt(0)
  s_branch L32
L31:
  s_waitcnt vmcnt(0) lgkmcnt(0)
  s_barrier
  s_lshl_b32 s3, s7, 7
  v_subrev_u32 v252, s3, v221
  ds_read_b64 v[242:243], v252 offset:0
  ds_read_b64 v[244:245], v252 offset:128
  ds_read_b64 v[246:247], v252 offset:256
  ds_read_b64 v[248:249], v252 offset:384
  s_waitcnt lgkmcnt(0)
  v_fmac_f32 v244, v228, v242
  v_fmac_f32 v245, v228, v243
  v_fma_f32 v244, -v229, v243, v244
  v_fmac_f32 v245, v229, v242
  v_fmac_f32 v246, v228, v244
  v_fmac_f32 v247, v228, v245
  v_fma_f32 v246, -v229, v245, v246
  v_fmac_f32 v247, v229, v244
  v_fmac_f32 v248, v228, v246
  v_fmac_f32 v249, v228, v247
  v_fma_f32 v248, -v229, v247, v248
  v_fmac_f32 v249, v229, v246
  v_cmp_eq_u32 vcc, -1, v248
  v_mov_b32 v252, 0x7fc00000
  s_nop 0
  v_cndmask_b32 v248, v248, v252, vcc
  v_cmp_eq_u32 vcc, -1, v249
  v_mov_b32 v252, 0x7fc00000
  s_nop 0
  v_cndmask_b32 v249, v249, v252, vcc
  v_and_b32 v252, 15, v220
  v_lshlrev_b32 v252, 3, v252
  s_lshl_b32 s3, s5, 8
  s_lshl_b32 s74, s70, 7
  s_add_u32 s3, s3, s74
  s_cmp_eq_u32 s7, 0
  s_cselect_b32 s3, s3, 0x10000
  v_add_u32 v252, s3, v252
  s_mov_b64 exec, 0xffff
  buffer_store_dwordx2 v[248:249], v252, s[88:91], 0 offen sc1
  s_mov_b64 exec, -1
  v_cndmask_b32 v250, 0, v242, s[82:83]
  v_cndmask_b32 v250, v250, v244, s[84:85]
  v_cndmask_b32 v250, v250, v246, s[86:87]
  v_cndmask_b32 v251, 0, v243, s[82:83]
  v_cndmask_b32 v251, v251, v245, s[84:85]
  v_cndmask_b32 v251, v251, v247, s[86:87]
  v_fmac_f32 v208, v236, v250
  v_fmac_f32 v209, v236, v251
  v_fma_f32 v208, -v237, v251, v208
  v_fmac_f32 v209, v237, v250
  v_lshrrev_b32 v211, 4, v220
  v_lshlrev_b32 v211, 10, v211
  v_and_b32 v242, 15, v220
  v_lshl_add_u32 v211, v242, 3, v211
  s_sub_u32 s3, s5, 16
  s_lshl_b32 s3, s3, 8
  s_lshl_b32 s74, s70, 7
  s_add_u32 s3, s3, s74
  v_add_u32 v211, s3, v211
  s_cmp_lg_u32 s6, 14
  s_cbranch_scc1 L33
  s_cmp_lg_u32 s70, 0
  s_cbranch_scc1 L33
  v_lshrrev_b32 v216, 5, v220
  v_lshlrev_b32 v216, 4, v216
  v_add_u32 v216, 148480, v216
  v_add_u32 v217, s38, v216
  ds_read_b128 v[176:179], v217 offset:0
  ds_read_b128 v[180:183], v217 offset:32
  ds_read_b128 v[184:187], v217 offset:64
  ds_read_b128 v[188:191], v217 offset:96
  v_add_u32 v217, s39, v216
  ds_read_b128 v[192:195], v217 offset:0
  ds_read_b128 v[196:199], v217 offset:32
  ds_read_b128 v[200:203], v217 offset:64
  ds_read_b128 v[204:207], v217 offset:96
  s_waitcnt lgkmcnt(0)
  v_mfma_f32_32x32x16_bf16 v[128:143], v[176:179], v[0:3], 0
  v_mfma_f32_32x32x16_bf16 v[128:143], v[180:183], v[4:7], v[128:143]
  v_mfma_f32_32x32x16_bf16 v[128:143], v[184:187], v[8:11], v[128:143]
  v_mfma_f32_32x32x16_bf16 v[128:143], v[188:191], v[12:15], v[128:143]
  v_mfma_f32_32x32x16_bf16 v[128:143], v[192:195], v[16:19], v[128:143]
  v_mfma_f32_32x32x16_bf16 v[128:143], v[196:199], v[20:23], v[128:143]
  v_mfma_f32_32x32x16_bf16 v[128:143], v[200:203], v[24:27], v[128:143]
  v_mfma_f32_32x32x16_bf16 v[128:143], v[204:207], v[28:31], v[128:143]
  s_nop 7
  v_add_u32 v217, s40, v216
  ds_read_b128 v[176:179], v217 offset:0
  ds_read_b128 v[180:183], v217 offset:32
  ds_read_b128 v[184:187], v217 offset:64
  ds_read_b128 v[188:191], v217 offset:96
  v_add_u32 v217, s41, v216
  ds_read_b128 v[192:195], v217 offset:0
  ds_read_b128 v[196:199], v217 offset:32
  ds_read_b128 v[200:203], v217 offset:64
  ds_read_b128 v[204:207], v217 offset:96
  s_waitcnt lgkmcnt(0)
  v_mfma_f32_32x32x16_bf16 v[128:143], v[176:179], v[32:35], v[128:143]
  v_mfma_f32_32x32x16_bf16 v[128:143], v[180:183], v[36:39], v[128:143]
  v_mfma_f32_32x32x16_bf16 v[128:143], v[184:187], v[40:43], v[128:143]
  v_mfma_f32_32x32x16_bf16 v[128:143], v[188:191], v[44:47], v[128:143]
  v_mfma_f32_32x32x16_bf16 v[128:143], v[192:195], v[48:51], v[128:143]
  v_mfma_f32_32x32x16_bf16 v[128:143], v[196:199], v[52:55], v[128:143]
  v_mfma_f32_32x32x16_bf16 v[128:143], v[200:203], v[56:59], v[128:143]
  v_mfma_f32_32x32x16_bf16 v[128:143], v[204:207], v[60:63], v[128:143]
  s_nop 7
  v_add_u32 v217, s42, v216
  ds_read_b128 v[176:179], v217 offset:0
  ds_read_b128 v[180:183], v217 offset:32
  ds_read_b128 v[184:187], v217 offset:64
  ds_read_b128 v[188:191], v217 offset:96
  v_add_u32 v217, s43, v216
  ds_read_b128 v[192:195], v217 offset:0
  ds_read_b128 v[196:199], v217 offset:32
  ds_read_b128 v[200:203], v217 offset:64
  ds_read_b128 v[204:207], v217 offset:96
  s_waitcnt lgkmcnt(0)
  v_mfma_f32_32x32x16_bf16 v[128:143], v[176:179], v[64:67], v[128:143]
  v_mfma_f32_32x32x16_bf16 v[128:143], v[180:183], v[68:71], v[128:143]
  v_mfma_f32_32x32x16_bf16 v[128:143], v[184:187], v[72:75], v[128:143]
  v_mfma_f32_32x32x16_bf16 v[128:143], v[188:191], v[76:79], v[128:143]
  v_mfma_f32_32x32x16_bf16 v[128:143], v[192:195], v[80:83], v[128:143]
  v_mfma_f32_32x32x16_bf16 v[128:143], v[196:199], v[84:87], v[128:143]
  v_mfma_f32_32x32x16_bf16 v[128:143], v[200:203], v[88:91], v[128:143]
  v_mfma_f32_32x32x16_bf16 v[128:143], v[204:207], v[92:95], v[128:143]
  s_nop 7
  v_add_u32 v217, s44, v216
  ds_read_b128 v[176:179], v217 offset:0
  ds_read_b128 v[180:183], v217 offset:32
  ds_read_b128 v[184:187], v217 offset:64
  ds_read_b128 v[188:191], v217 offset:96
  v_add_u32 v217, s45, v216
  ds_read_b128 v[192:195], v217 offset:0
  ds_read_b128 v[196:199], v217 offset:32
  ds_read_b128 v[200:203], v217 offset:64
  ds_read_b128 v[204:207], v217 offset:96
  s_waitcnt lgkmcnt(0)
  v_mfma_f32_32x32x16_bf16 v[128:143], v[176:179], v[96:99], v[128:143]
  v_mfma_f32_32x32x16_bf16 v[128:143], v[180:183], v[100:103], v[128:143]
  v_mfma_f32_32x32x16_bf16 v[128:143], v[184:187], v[104:107], v[128:143]
  v_mfma_f32_32x32x16_bf16 v[128:143], v[188:191], v[108:111], v[128:143]
  v_mfma_f32_32x32x16_bf16 v[128:143], v[192:195], v[112:115], v[128:143]
  v_mfma_f32_32x32x16_bf16 v[128:143], v[196:199], v[116:119], v[128:143]
  v_mfma_f32_32x32x16_bf16 v[128:143], v[200:203], v[120:123], v[128:143]
  v_mfma_f32_32x32x16_bf16 v[128:143], v[204:207], v[124:127], v[128:143]
  s_nop 7
  s_lshl_b32 s3, s5, 2
  s_add_u32 s3, s3, s7
  s_lshl_b32 s3, s3, 7
  s_add_u32 s3, s3, 12648448
  v_and_b32 v216, 31, v220
  v_lshlrev_b32 v216, 2, v216
  s_nop 15
  s_nop 3
  v_cvt_pk_bf16_f32 v128, v128, v128
  v_lshlrev_b32 v128, 16, v128
  v_mul_f32 v128, 0xbfb8aa3b, v128
  v_exp_f32 v128, v128
  s_nop 0
  v_add_f32 v128, 1.0, v128
  v_rcp_f32 v128, v128
  s_nop 0
  v_cvt_pk_bf16_f32 v128, v128, v128
  v_lshlrev_b32 v128, 16, v128
  buffer_store_dword v128, v216, s[28:31], s3 offen sc1
L33:
  v_add_u32 v242, 0, v211
  v_add_u32 v244, 256, v211
  v_add_u32 v246, 512, v211
  v_add_u32 v248, 768, v211
  buffer_load_dwordx2 v[242:243], v242, s[88:91], 0 offen sc1
  buffer_load_dwordx2 v[244:245], v244, s[88:91], 0 offen sc1
  buffer_load_dwordx2 v[246:247], v246, s[88:91], 0 offen sc1
  buffer_load_dwordx2 v[248:249], v248, s[88:91], 0 offen sc1
  s_waitcnt vmcnt(0)
  s_mov_b32 s94, 0
L35:
  v_max3_u32 v250, v242, v243, v244
  v_max3_u32 v250, v250, v245, v246
  v_max3_u32 v250, v250, v247, v248
  v_max_u32 v250, v250, v249
  v_cmp_eq_u32 vcc, -1, v250
  s_add_u32 s94, s94, 1
  s_nop 3
  s_cbranch_vccz L34
  s_cmp_ge_u32 s94, 0x8000
  s_cbranch_scc1 L34
  s_sleep 1
  v_add_u32 v242, 0, v211
  v_add_u32 v244, 256, v211
  v_add_u32 v246, 512, v211
  v_add_u32 v248, 768, v211
  buffer_load_dwordx2 v[242:243], v242, s[88:91], 0 offen sc1
  buffer_load_dwordx2 v[244:245], v244, s[88:91], 0 offen sc1
  buffer_load_dwordx2 v[246:247], v246, s[88:91], 0 offen sc1
  buffer_load_dwordx2 v[248:249], v248, s[88:91], 0 offen sc1
  s_waitcnt vmcnt(0)
  s_branch L35
L34:
  v_fmac_f32 v244, v230, v242
  v_fmac_f32 v245, v230, v243
  v_fma_f32 v244, -v231, v243, v244
  v_fmac_f32 v245, v231, v242
  v_fmac_f32 v246, v230, v244
  v_fmac_f32 v247, v230, v245
  v_fma_f32 v246, -v231, v245, v246
  v_fmac_f32 v247, v231, v244
  v_fmac_f32 v248, v230, v246
  v_fmac_f32 v249, v230, v247
  v_fma_f32 v248, -v231, v247, v248
  v_fmac_f32 v249, v231, v246
  v_mov_b32 v242, v248
  v_mov_b32 v243, v249
  s_nop 1
  v_permlane16_swap_b32 v242, v248
  v_permlane16_swap_b32 v243, v249
  s_nop 0
  v_fmac_f32 v248, v232, v242
  v_fmac_f32 v249, v232, v243
  v_fma_f32 v248, -v233, v243, v248
  v_fmac_f32 v249, v233, v242
  v_mov_b32 v244, v248
  v_mov_b32 v245, v249
  s_nop 1
  v_permlane32_swap_b32 v244, v248
  v_permlane32_swap_b32 v245, v249
  s_nop 0
  v_fmac_f32 v248, v234, v244
  v_fmac_f32 v249, v234, v245
  v_fma_f32 v248, -v235, v245, v248
  v_fmac_f32 v249, v235, v244
  v_fmac_f32 v208, v238, v248
  v_fmac_f32 v209, v238, v249
  v_fma_f32 v208, -v239, v249, v208
  v_fmac_f32 v209, v239, v248
  v_fmac_f32 v160, v222, v208
  v_fmac_f32 v168, v222, v209
  v_fma_f32 v160, -v223, v209, v160
  v_fmac_f32 v168, v223, v208
  v_fmac_f32 v161, v222, v160
  v_fmac_f32 v169, v222, v168
  v_fma_f32 v161, -v223, v168, v161
  v_fmac_f32 v169, v223, v160
  v_fmac_f32 v162, v222, v161
  v_fmac_f32 v170, v222, v169
  v_fma_f32 v162, -v223, v169, v162
  v_fmac_f32 v170, v223, v161
  v_fmac_f32 v163, v222, v162
  v_fmac_f32 v171, v222, v170
  v_fma_f32 v163, -v223, v170, v163
  v_fmac_f32 v171, v223, v162
  v_fmac_f32 v164, v222, v163
  v_fmac_f32 v172, v222, v171
  v_fma_f32 v164, -v223, v171, v164
  v_fmac_f32 v172, v223, v163
  v_fmac_f32 v165, v222, v164
  v_fmac_f32 v173, v222, v172
  v_fma_f32 v165, -v223, v172, v165
  v_fmac_f32 v173, v223, v164
  v_fmac_f32 v166, v222, v165
  v_fmac_f32 v174, v222, v173
  v_fma_f32 v166, -v223, v173, v166
  v_fmac_f32 v174, v223, v165
  v_fmac_f32 v167, v222, v166
  v_fmac_f32 v175, v222, v174
  v_fma_f32 v167, -v223, v174, v167
  v_fmac_f32 v175, v223, v166
  v_and_b32 v250, 15, v220
  v_lshlrev_b32 v250, 6, v250
  v_and_or_b32 v250, v220, 48, v250
  s_add_u32 s3, s71, 131072
  v_add_u32 v250, s3, v250
  v_lshrrev_b32 v251, 5, v220
  v_bfe_u32 v252, v220, 2, 2
  v_lshl_add_u32 v251, v251, 3, v252
  v_lshlrev_b32 v251, 6, v251
  v_and_b32 v252, 1, v220
  v_lshl_add_u32 v251, v252, 5, v251
  v_and_or_b32 v251, v220, 16, v251
  v_and_b32 v252, 2, v220
  v_lshl_add_u32 v251, v252, 2, v251
  s_add_u32 s3, s71, 131072
  v_add_u32 v251, s3, v251
  v_cvt_pk_bf16_f32 v242, v160, v161
  v_cvt_pk_bf16_f32 v243, v162, v163
  v_cvt_pk_bf16_f32 v244, v164, v165
  v_cvt_pk_bf16_f32 v245, v166, v167
  v_cvt_pk_bf16_f32 v246, -v168, -v169
  v_cvt_pk_bf16_f32 v247, -v170, -v171
  v_cvt_pk_bf16_f32 v248, -v172, -v173
  v_cvt_pk_bf16_f32 v249, -v174, -v175
  ds_write_b128 v250, v[242:245] offset:0
  ds_write_b128 v250, v[246:249] offset:1024
  s_waitcnt lgkmcnt(0)
  ds_read_b64_tr_b16 v[160:161], v251 offset:0
  ds_read_b64_tr_b16 v[162:163], v251 offset:256
  ds_read_b64_tr_b16 v[164:165], v251 offset:1024
  ds_read_b64_tr_b16 v[166:167], v251 offset:1280
  s_waitcnt lgkmcnt(0)
  s_add_u32 s74, s95, 0
  buffer_store_dwordx4 v[160:163], v219, s[28:31], s74 offen sc1
  s_add_u32 s74, s95, 32768
  buffer_store_dwordx4 v[164:167], v219, s[28:31], s74 offen sc1
  s_waitcnt vmcnt(0) lgkmcnt(0)
  s_barrier
  s_cmp_lg_u32 s4, 0
  s_cbranch_scc1 L36
  s_lshl_b32 s3, s5, 11
  s_add_u32 s3, s3, s6
  s_lshl_b32 s3, s3, 2
  s_add_u32 s3, s3, 12718080
  v_mov_b32 v254, 3
  s_mov_b64 exec, 1
  buffer_store_dword v254, off, s[28:31], s3 sc1
  s_mov_b64 exec, -1
L36:
  s_and_b32 s98, s2, 7
  s_lshl_b32 s98, s98, 2
  s_lshr_b32 s3, s2, 6
  s_add_u32 s98, s98, s3
  s_bfe_u32 s99, s2, 0x30003
  s_lshl_b32 s3, s3, 1
  s_add_u32 s3, s3, s99
  s_cmp_ge_u32 s3, 7
  s_cselect_b32 s74, 7, 0
  s_sub_u32 s3, s3, s74
  s_lshl_b32 s38, s3, 13
  s_add_u32 s3, s38, 8192
  s_cmp_ge_u32 s3, 57344
  s_cselect_b32 s39, 0, s3
  s_add_u32 s3, s39, 8192
  s_cmp_ge_u32 s3, 57344
  s_cselect_b32 s40, 0, s3
  s_add_u32 s3, s40, 8192
  s_cmp_ge_u32 s3, 57344
  s_cselect_b32 s41, 0, s3
  s_add_u32 s3, s41, 8192
  s_cmp_ge_u32 s3, 57344
  s_cselect_b32 s42, 0, s3
  s_add_u32 s3, s42, 8192
  s_cmp_ge_u32 s3, 57344
  s_cselect_b32 s43, 0, s3
  s_add_u32 s3, s43, 8192
  s_cmp_ge_u32 s3, 57344
  s_cselect_b32 s44, 0, s3
  s_mul_i32 s3, s70, 56
  s_add_u32 s3, s3, s7
  s_lshl_b32 s96, s3, 14
  s_add_u32 s97, s96, 65536
  s_lshl_b32 s3, s3, 10
  s_mul_i32 s73, s98, 360448
  s_add_u32 s100, s73, s3
  s_add_u32 s101, s100, 4096
  s_lshr_b32 s45, s98, 1
  s_lshl_b32 s45, s45, 13
  s_add_u32 s45, s45, 12718080
  s_mov_b32 s8, s60
  s_mov_b32 s9, s61
  s_mov_b32 s10, 1835008
  s_mov_b32 s11, 0x20000
  v_lshrrev_b32 v254, 3, v220
  v_and_b32 v252, 2, v254
  v_lshlrev_b32 v252, 1, v252
  v_xor_b32 v252, v252, v220
  v_and_b32 v252, 7, v252
  s_lshl_b32 s3, s99, 7
  v_lshl_add_u32 v252, v252, 4, s3
  v_lshl_add_u32 v218, v254, 10, v252
  v_add_u32 v253, 7168, v218
  v_add_u32 v214, 180224, v219
  v_lshrrev_b32 v252, 5, v220
  v_bfe_u32 v254, v220, 2, 2
  v_lshl_add_u32 v252, v252, 2, v254
  v_lshl_add_u32 v252, v252, 7, s71
  v_bfe_u32 v254, v220, 3, 1
  v_lshl_add_u32 v252, v254, 6, v252
  v_bfe_u32 v254, v220, 4, 1
  v_lshl_add_u32 v252, v254, 5, v252
  v_and_b32 v254, 3, v220
  v_lshl_add_u32 v215, v254, 3, v252
  v_and_b32 v210, 15, v220
  v_lshlrev_b32 v210, 2, v210
  buffer_load_dword v210, v210, s[28:31], s45 offen sc1
  s_add_u32 m0, s71, 32768
  s_lshl4_add_u32 s74, s38, s96
  buffer_load_dwordx4 v218, s[8:11], s74 offen lds
  s_lshl4_add_u32 s74, s38, s96
  buffer_load_dwordx4 v253, s[8:11], s74 offen offset:1024 lds
  s_add_u32 m0, s71, 98304
  s_lshl4_add_u32 s74, s39, s96
  buffer_load_dwordx4 v218, s[8:11], s74 offen lds
  s_lshl4_add_u32 s74, s39, s96
  buffer_load_dwordx4 v253, s[8:11], s74 offen offset:1024 lds
  s_add_u32 m0, s71, 49152
  s_lshl4_add_u32 s74, s40, s96
  buffer_load_dwordx4 v218, s[8:11], s74 offen lds
  s_lshl4_add_u32 s74, s40, s96
  buffer_load_dwordx4 v253, s[8:11], s74 offen offset:1024 lds
  s_add_u32 m0, s71, 114688
  s_lshl4_add_u32 s74, s41, s96
  buffer_load_dwordx4 v218, s[8:11], s74 offen lds
  s_lshl4_add_u32 s74, s41, s96
  buffer_load_dwordx4 v253, s[8:11], s74 offen offset:1024 lds
  s_add_u32 m0, s71, 147456
  s_lshl4_add_u32 s74, s42, s96
  buffer_load_dwordx4 v218, s[8:11], s74 offen lds
  s_lshl4_add_u32 s74, s42, s96
  buffer_load_dwordx4 v253, s[8:11], s74 offen offset:1024 lds
  s_add_u32 m0, s71, 0
  s_lshl4_add_u32 s74, s43, s96
  buffer_load_dwordx4 v218, s[8:11], s74 offen lds
  s_lshl4_add_u32 s74, s43, s96
  buffer_load_dwordx4 v253, s[8:11], s74 offen offset:1024 lds
  s_add_u32 m0, s71, 65536
  s_lshl4_add_u32 s74, s44, s96
  buffer_load_dwordx4 v218, s[8:11], s74 offen lds
  s_lshl4_add_u32 s74, s44, s96
  buffer_load_dwordx4 v253, s[8:11], s74 offen offset:1024 lds
  s_add_u32 m0, s71, 16384
  s_lshl4_add_u32 s74, s38, s97
  buffer_load_dwordx4 v218, s[8:11], s74 offen lds
  s_lshl4_add_u32 s74, s38, s97
  buffer_load_dwordx4 v253, s[8:11], s74 offen offset:1024 lds
  s_add_u32 m0, s71, 81920
  s_lshl4_add_u32 s74, s39, s97
  buffer_load_dwordx4 v218, s[8:11], s74 offen lds
  s_lshl4_add_u32 s74, s39, s97
  buffer_load_dwordx4 v253, s[8:11], s74 offen offset:1024 lds
  s_add_u32 m0, s71, 131072
  s_lshl4_add_u32 s74, s40, s97
  buffer_load_dwordx4 v218, s[8:11], s74 offen lds
  s_lshl4_add_u32 s74, s40, s97
  buffer_load_dwordx4 v253, s[8:11], s74 offen offset:1024 lds
  s_waitcnt vmcnt(20)
  s_mov_b32 s94, 0
L38:
  v_cmp_gt_i32 vcc, 1, v210
  s_add_u32 s94, s94, 1
  s_nop 2
  s_and_b32 s3, vcc_lo, 0x3fff
  s_cbranch_scc0 L37
  s_cmp_ge_u32 s94, 0x8000
  s_cbranch_scc1 L37
  s_sleep 2
  v_and_b32 v210, 15, v220
  v_lshlrev_b32 v210, 2, v210
  buffer_load_dword v210, v210, s[28:31], s45 offen sc1
  s_waitcnt vmcnt(0)
  s_branch L38
L37:
  s_add_u32 s74, s100, s38
  buffer_load_dwordx4 v[0:3], v219, s[28:31], s74 offen sc1
  s_add_u32 s74, s100, s38
  buffer_load_dwordx4 v[4:7], v214, s[28:31], s74 offen sc1
  s_add_u32 s74, s100, s39
  buffer_load_dwordx4 v[8:11], v219, s[28:31], s74 offen sc1
  s_add_u32 s74, s100, s39
  buffer_load_dwordx4 v[12:15], v214, s[28:31], s74 offen sc1
  s_add_u32 s74, s100, s40
  buffer_load_dwordx4 v[16:19], v219, s[28:31], s74 offen sc1
  s_add_u32 s74, s100, s40
  buffer_load_dwordx4 v[20:23], v214, s[28:31], s74 offen sc1
  s_add_u32 s74, s100, s41
  buffer_load_dwordx4 v[24:27], v219, s[28:31], s74 offen sc1
  s_add_u32 s74, s100, s41
  buffer_load_dwordx4 v[28:31], v214, s[28:31], s74 offen sc1
  s_add_u32 s74, s100, s42
  buffer_load_dwordx4 v[32:35], v219, s[28:31], s74 offen sc1
  s_add_u32 s74, s100, s42
  buffer_load_dwordx4 v[36:39], v214, s[28:31], s74 offen sc1
  s_add_u32 s74, s100, s43
  buffer_load_dwordx4 v[40:43], v219, s[28:31], s74 offen sc1
  s_add_u32 s74, s100, s43
  buffer_load_dwordx4 v[44:47], v214, s[28:31], s74 offen sc1
  s_add_u32 s74, s100, s44
  buffer_load_dwordx4 v[48:51], v219, s[28:31], s74 offen sc1
  s_add_u32 s74, s100, s44
  buffer_load_dwordx4 v[52:55], v214, s[28:31], s74 offen sc1
  s_waitcnt vmcnt(32)
  v_xor_b32 v216, 64, v215
  v_add_u32 v212, 0x10000, v215
  v_add_u32 v213, 0x10000, v216
  v_add_u32 v217, 0x20000, v215
  v_add_u32 v221, 0x20000, v216
  ds_read_b64_tr_b16 v[176:177], v215 offset:32768
  ds_read_b64_tr_b16 v[178:179], v215 offset:33792
  ds_read_b64_tr_b16 v[180:181], v216 offset:32768
  ds_read_b64_tr_b16 v[182:183], v216 offset:33792
  s_waitcnt lgkmcnt(0)
  s_waitcnt vmcnt(12)
  v_mfma_f32_32x32x16_bf16 v[64:79], v[176:179], v[0:3], 0
  ds_read_b64_tr_b16 v[184:185], v212 offset:32768
  ds_read_b64_tr_b16 v[186:187], v212 offset:33792
  ds_read_b64_tr_b16 v[188:189], v213 offset:32768
  v_mfma_f32_32x32x16_bf16 v[80:95], v[176:179], v[4:7], 0
  ds_read_b64_tr_b16 v[190:191], v213 offset:33792
  v_mfma_f32_32x32x16_bf16 v[96:111], v[180:183], v[0:3], 0
  v_mfma_f32_32x32x16_bf16 v[112:127], v[180:183], v[4:7], 0
  s_waitcnt lgkmcnt(0)
  s_waitcnt vmcnt(10)
  v_mfma_f32_32x32x16_bf16 v[64:79], v[184:187], v[8:11], v[64:79]
  ds_read_b64_tr_b16 v[176:177], v215 offset:49152
  ds_read_b64_tr_b16 v[178:179], v215 offset:50176
  ds_read_b64_tr_b16 v[180:181], v216 offset:49152
  v_mfma_f32_32x32x16_bf16 v[80:95], v[184:187], v[12:15], v[80:95]
  ds_read_b64_tr_b16 v[182:183], v216 offset:50176
  v_mfma_f32_32x32x16_bf16 v[96:111], v[188:191], v[8:11], v[96:111]
  v_mfma_f32_32x32x16_bf16 v[112:127], v[188:191], v[12:15], v[112:127]
  s_waitcnt lgkmcnt(0)
  s_waitcnt vmcnt(8)
  s_add_u32 m0, s71, 32768
  s_lshl4_add_u32 s74, s41, s97
  v_mfma_f32_32x32x16_bf16 v[64:79], v[176:179], v[16:19], v[64:79]
  ds_read_b64_tr_b16 v[184:185], v212 offset:49152
  ds_read_b64_tr_b16 v[186:187], v212 offset:50176
  ds_read_b64_tr_b16 v[188:189], v213 offset:49152
  buffer_load_dwordx4 v218, s[8:11], s74 offen lds
  s_lshl4_add_u32 s74, s41, s97
  v_mfma_f32_32x32x16_bf16 v[80:95], v[176:179], v[20:23], v[80:95]
  ds_read_b64_tr_b16 v[190:191], v213 offset:50176
  buffer_load_dwordx4 v253, s[8:11], s74 offen offset:1024 lds
  s_add_u32 m0, s71, 98304
  s_lshl4_add_u32 s74, s42, s97
  v_mfma_f32_32x32x16_bf16 v[96:111], v[180:183], v[16:19], v[96:111]
  buffer_load_dwordx4 v218, s[8:11], s74 offen lds
  s_lshl4_add_u32 s74, s42, s97
  v_mfma_f32_32x32x16_bf16 v[112:127], v[180:183], v[20:23], v[112:127]
  buffer_load_dwordx4 v253, s[8:11], s74 offen offset:1024 lds
  s_waitcnt lgkmcnt(0)
  s_waitcnt vmcnt(10)
  v_mfma_f32_32x32x16_bf16 v[64:79], v[184:187], v[24:27], v[64:79]
  ds_read_b64_tr_b16 v[176:177], v217 offset:16384
  ds_read_b64_tr_b16 v[178:179], v217 offset:17408
  ds_read_b64_tr_b16 v[180:181], v221 offset:16384
  v_mfma_f32_32x32x16_bf16 v[80:95], v[184:187], v[28:31], v[80:95]
  ds_read_b64_tr_b16 v[182:183], v221 offset:17408
  v_mfma_f32_32x32x16_bf16 v[96:111], v[188:191], v[24:27], v[96:111]
  v_mfma_f32_32x32x16_bf16 v[112:127], v[188:191], v[28:31], v[112:127]
  s_waitcnt lgkmcnt(0)
  s_waitcnt vmcnt(8)
  s_add_u32 m0, s71, 49152
  s_lshl4_add_u32 s74, s43, s97
  v_mfma_f32_32x32x16_bf16 v[64:79], v[176:179], v[32:35], v[64:79]
  ds_read_b64_tr_b16 v[184:185], v215 offset:0
  ds_read_b64_tr_b16 v[186:187], v215 offset:1024
  ds_read_b64_tr_b16 v[188:189], v216 offset:0
  buffer_load_dwordx4 v218, s[8:11], s74 offen lds
  s_lshl4_add_u32 s74, s43, s97
  v_mfma_f32_32x32x16_bf16 v[80:95], v[176:179], v[36:39], v[80:95]
  ds_read_b64_tr_b16 v[190:191], v216 offset:1024
  buffer_load_dwordx4 v253, s[8:11], s74 offen offset:1024 lds
  s_add_u32 m0, s71, 114688
  s_lshl4_add_u32 s74, s44, s97
  v_mfma_f32_32x32x16_bf16 v[96:111], v[180:183], v[32:35], v[96:111]
  buffer_load_dwordx4 v218, s[8:11], s74 offen lds
  s_lshl4_add_u32 s74, s44, s97
  v_mfma_f32_32x32x16_bf16 v[112:127], v[180:183], v[36:39], v[112:127]
  buffer_load_dwordx4 v253, s[8:11], s74 offen offset:1024 lds
  s_waitcnt lgkmcnt(0)
  s_waitcnt vmcnt(10)
  v_mfma_f32_32x32x16_bf16 v[64:79], v[184:187], v[40:43], v[64:79]
  ds_read_b64_tr_b16 v[176:177], v212 offset:0
  ds_read_b64_tr_b16 v[178:179], v212 offset:1024
  ds_read_b64_tr_b16 v[180:181], v213 offset:0
  v_mfma_f32_32x32x16_bf16 v[80:95], v[184:187], v[44:47], v[80:95]
  ds_read_b64_tr_b16 v[182:183], v213 offset:1024
  v_mfma_f32_32x32x16_bf16 v[96:111], v[188:191], v[40:43], v[96:111]
  v_mfma_f32_32x32x16_bf16 v[112:127], v[188:191], v[44:47], v[112:127]
  s_waitcnt lgkmcnt(0)
  s_waitcnt vmcnt(8)
  v_mfma_f32_32x32x16_bf16 v[64:79], v[176:179], v[48:51], v[64:79]
  v_mfma_f32_32x32x16_bf16 v[80:95], v[176:179], v[52:55], v[80:95]
  v_mfma_f32_32x32x16_bf16 v[96:111], v[180:183], v[48:51], v[96:111]
  v_mfma_f32_32x32x16_bf16 v[112:127], v[180:183], v[52:55], v[112:127]
  s_waitcnt vmcnt(0) lgkmcnt(0)
  s_branch Lp1end
.section .rodata,"a"
.p2align 6
.amdhsa_kernel gated_mix__ssm_conv_s5__glu_gated_swiglu__prompt_kernel
  .amdhsa_next_free_vgpr 256
  .amdhsa_next_free_sgpr 102
  .amdhsa_accum_offset 256
  .amdhsa_group_segment_fixed_size 0
  .amdhsa_kernarg_size 136
  .amdhsa_user_sgpr_count 2
  .amdhsa_user_sgpr_kernarg_segment_ptr 1
  .amdhsa_system_sgpr_workgroup_id_x 1
.end_amdhsa_kernel
```
